```python
import torch

def _softmax(x, axis=-1):
    return torch.softmax(x, dim=axis)
def _gelu(x):
    return torch.nn.functional.gelu(x, approximate="tanh")
def _silu(x):
    return torch.nn.functional.silu(x)
def _sigmoid(x):
    return torch.sigmoid(x)
def _layernorm(x, axis=-1, eps=1e-5):
    m = x.mean(dim=axis, keepdim=True)
    v = x.var(dim=axis, keepdim=True, unbiased=False)
    return (x - m) / torch.sqrt(v + eps)
def _scatter_add(tgt, idx, src, axis=0):
    return tgt.clone().index_add_(axis, idx, src)
def _segment_sum(src, seg, n):
    out = torch.zeros((n,) + src.shape[1:], dtype=src.dtype)
    return out.index_add_(0, seg, src)
def _pad(x, pw):
    flat = tuple(v for pair in reversed(pw) for v in pair)
    return torch.nn.functional.pad(x, flat)

kernel_name = 'gated_mix__sliding_block__mixer_channel_mlp__prompt'

def setup_inputs():

    _w = (lambda a: (lambda t: t.to(torch.bfloat16) if t.is_floating_point() else t)(torch.as_tensor(a)))
    def _A_setup():
        B, S, D = 1, 2048, 512
        return {
            "x": _w((lambda *s: torch.randn(*s, dtype=torch.bfloat16) * 0.05)(B, S, D)),
            "wqkv": _w((lambda *s: torch.randn(*s, dtype=torch.bfloat16) * 0.8)(D, 3 * D)),
            "wo": _w((lambda *s: torch.randn(*s, dtype=torch.bfloat16) * 0.05)(D, D)),
        }
    _A_in = _A_setup()

    def _B_setup():
        B, S, D, F = 1, 2048, 512, 1792
        return {
            "x": _w((lambda *s: torch.randn(*s, dtype=torch.bfloat16) * 0.05)(B, S, D)),
            "w1": _w((lambda *s: torch.randn(*s, dtype=torch.bfloat16) * 3.2)(D, F) * (D ** -0.5)),
            "b1": _w((lambda *s: torch.randn(*s, dtype=torch.bfloat16) * 1.6)(F)),
            "w2": _w((lambda *s: torch.randn(*s, dtype=torch.bfloat16) * 0.1)(F, D) * (F ** -0.5)),
            "b2": _w((lambda *s: torch.randn(*s, dtype=torch.bfloat16) * 0.2)(D)),
        }
    _B_in = _B_setup()

    return {
        "A_x": _A_in["x"],
        "A_wqkv": _A_in["wqkv"],
        "A_wo": _A_in["wo"],
        "B_x": _B_in["x"],
        "B_w1": _B_in["w1"],
        "B_b1": _B_in["b1"],
        "B_w2": _B_in["w2"],
        "B_b2": _B_in["b2"],
        "gate_w": _w((lambda *s: torch.randn(*s, dtype=torch.bfloat16) * 0.05)(512) * 16.0),
    }

def reference(A_x, A_wqkv, A_wo, B_x, B_w1, B_b1, B_w2, B_b2, gate_w):
    def _A_ref(x, wqkv, wo):
        B, S, D = x.shape
        H = 32; Dh = D // H; W = 256
        qkv = (lambda x, *d: x.permute(*d))((x @ wqkv).reshape(B, S, 3, H, Dh), 2, 0, 3, 1, 4)
        q, k, v = qkv[0], qkv[1], qkv[2]
        scores = torch.einsum("bhqd,bhkd->bhqk", q, k) * (Dh ** -0.5)
        idx = torch.arange(S)
        mask = (idx[:, None] - idx[None, :] >= 0) & (idx[:, None] - idx[None, :] < W)
        scores = torch.where(mask[None, None], scores, -1e9)
        p = _softmax(scores, axis=-1)
        o = torch.einsum("bhqk,bhkd->bhqd", p, v)
        return (lambda x, *d: x.permute(*d))(o, 0, 2, 1, 3).reshape(B, S, D) @ wo

    def _B_ref(x, w1, b1, w2, b2):
        y = _layernorm(x, axis=-1)
        h = _gelu(torch.einsum("bsd,df->bsf", y, w1) + b1)
        return torch.einsum("bsf,fd->bsd", h, w2) + b2

    x = A_x
    g = _sigmoid((x * gate_w).sum(-1, keepdims=True))
    a = _A_ref(x, A_wqkv, A_wo)
    b = _B_ref(x, B_w1, B_b1, B_w2, B_b2)
    return g * a + (1 - g) * b
```

```asm
; @launch grid=(256,1,1) block=(256,1,1) lds=163840
.amdgcn_target "amdgcn-amd-amdhsa--gfx950"
.text
.globl gated_mix__sliding_block__mixer_channel_mlp__prompt_kernel
.p2align 8
.type gated_mix__sliding_block__mixer_channel_mlp__prompt_kernel,@function
gated_mix__sliding_block__mixer_channel_mlp__prompt_kernel:
    s_load_dwordx4 s[8:11], s[0:1], 0
    s_load_dwordx2 s[16:17], s[0:1], 32
    s_load_dwordx2 s[20:21], s[0:1], 88
    s_getpc_b64 s[6:7]
    s_cmp_ge_u32 s2, 256
    s_cbranch_scc1 L_END
    s_bfe_u32 s3, s2, 0x40003
    s_lshl_b32 s3, s3, 12
    v_lshl_add_u32 v1, v0, 4, s3
    v_min_u32 v1, CODE_BYTES-64, v1
    global_load_dwordx4 a[220:223], v1, s[6:7]
    v_lshrrev_b32 v1, 6, v0
    s_and_b32 s96, s2, 1
    v_readfirstlane_b32 s52, v1
    v_and_b32 v0, 63, v0
    s_bfe_u32 s97, s2, 0x20001
    s_bfe_u32 s53, s2, 0x20005
    s_bfe_u32 s98, s2, 0x10003
    s_lshl1_add_u32 s53, s53, s98
    s_lshl1_add_u32 s74, s96, s98
    s_xor_b32 s74, s74, s97
    s_lshl_b32 s74, s74, 1
    s_lshl3_add_u32 s53, s96, s53
    s_lshl2_add_u32 s56, s53, s52
    s_lshl_b32 s75, s56, 8
    s_or_b32 s75, s75, s74
    s_lshl_b32 s75, s75, 7
    s_lshl_b32 s60, s52, 12
    v_and_b32 v138, 7, v0
    v_lshrrev_b32 v137, 4, v0
    v_xor_b32 v136, v138, v137
    v_lshlrev_b32 v136, 4, v136
    v_lshrrev_b32 v137, 3, v0
    v_lshl_add_u32 v2, v137, 10, v136
    s_movk_i32 s94, 7168
    v_xad_u32 v3, v2, 64, s94
    v_lshl_add_u32 v4, s94, 1, v2
    v_lshl_add_u32 v5, s94, 1, v3
    s_waitcnt lgkmcnt(0)
    s_mov_b64 s[12:13], s[10:11]
    s_mov_b32 s10, 2097152
    s_mov_b32 s11, 0x20000
    s_add_u32 m0, s60, 65536
    s_xor_b32 s57, s75, 0
    buffer_load_dwordx4 v2, s[8:11], s57 offen lds
    buffer_load_dwordx4 v3, s[8:11], s57 offen offset:1024 lds
    buffer_load_dwordx4 v4, s[8:11], s57 offen offset:2048 lds
    buffer_load_dwordx4 v5, s[8:11], s57 offen offset:3072 lds
    s_load_dwordx2 s[28:29], s[0:1], 64
    s_load_dwordx2 s[24:25], s[0:1], 40
    s_load_dwordx2 s[32:33], s[0:1], 48
    s_load_dwordx2 s[36:37], s[0:1], 16
    s_load_dwordx2 s[40:41], s[0:1], 56
    s_load_dwordx2 s[44:45], s[0:1], 72
    s_load_dwordx2 s[48:49], s[0:1], 80
    s_bfe_u32 s99, s2, 0x10004
    s_lshr_b32 s55, s2, 7
    s_lshl1_add_u32 s55, s97, s55
    s_lshl1_add_u32 s54, s55, s99
    s_mul_i32 s94, s55, 7
    s_bitcmp1_b32 s55, 0
    s_cselect_b32 s67, 3, 0
    s_cselect_b32 s68, 1, 4
    s_cselect_b32 s69, 0, 6
    s_add_u32 s67, s67, s94
    s_add_u32 s98, s99, 1
    s_lshl3_add_u32 s98, s98, s55
    s_lshl_b32 s98, s98, 7
    s_mul_i32 s100, s52, 49152
    s_add_u32 s98, s98, s100
    s_mov_b32 s14, 1572864
    s_mov_b32 s15, 0x20000
    v_lshrrev_b32 v136, 2, v0
    v_and_b32 v136, 4, v136
    v_xor_b32 v136, v136, v138
    v_mul_u32_u24 v6, 3072, v137
    v_lshl_add_u32 v6, v136, 4, v6
    v_add_u32 v7, 23552, v6
    v_add_u32 v26, s98, v6
    v_add_u32 v27, s98, v7
    s_lshl_b32 s61, s52, 11
    s_add_u32 s61, s61, 0x20000
    s_xor_b32 s58, s74, 0
    s_add_u32 m0, s61, 0
    s_mul_i32 s58, s58, 196608
    buffer_load_dwordx4 v26, s[12:15], s58 offen lds
    buffer_load_dwordx4 v27, s[12:15], s58 offen offset:1024 lds
    s_mov_b32 s22, 268435456
    s_mov_b32 s23, 0x20000
    s_or_b32 s98, s2, s52
    s_cselect_b32 s79, 0x40000000, 0
    v_mov_b32 v108, s79
    s_mov_b32 s79, 19922944
    buffer_load_dword v109, v108, s[20:23], s79 offen sc1
    s_add_u32 s68, s68, s94
    s_add_u32 s69, s69, s94
    v_lshlrev_b32 v1, 4, v0
    s_add_u32 m0, s60, 81920
    s_xor_b32 s57, s75, 128
    buffer_load_dwordx4 v2, s[8:11], s57 offen lds
    buffer_load_dwordx4 v3, s[8:11], s57 offen offset:1024 lds
    buffer_load_dwordx4 v4, s[8:11], s57 offen offset:2048 lds
    buffer_load_dwordx4 v5, s[8:11], s57 offen offset:3072 lds
    s_xor_b32 s58, s74, 1
    s_add_u32 m0, s61, 8192
    s_mul_i32 s58, s58, 196608
    buffer_load_dwordx4 v26, s[12:15], s58 offen lds
    buffer_load_dwordx4 v27, s[12:15], s58 offen offset:1024 lds
    s_waitcnt lgkmcnt(0)
    s_mov_b32 s30, 1024
    s_mov_b32 s31, 0x20000
    s_lshl_b32 s100, s56, 5
    s_lshl1_add_u32 s100, s54, s100
    s_lshl_b32 s100, s100, 10
    s_mov_b32 s89, s100
    s_mov_b32 s18, 1835008
    s_mov_b32 s19, 0x20000
    s_mov_b32 s26, 3584
    s_mov_b32 s27, 0x20000
    s_mov_b32 s42, 1024
    s_mov_b32 s43, 0x20000
    s_add_u32 s94, s67, 2
    s_bitcmp1_b32 s54, 0
    s_cselect_b32 s68, s94, s68
    s_cselect_b32 s97, s67, s69
    s_cselect_b32 s98, 0x40000000, 0
    s_sub_u32 s96, s97, s68
    v_lshrrev_b32 v148, 5, v0
    v_mul_i32_i24 v148, s96, v148
    v_add_lshl_u32 v148, v148, s68, 6
    v_bfe_u32 v137, v0, 2, 3
    v_mul_u32_u24 v137, 3584, v137
    v_add_u32 v148, v148, v137
    s_mul_i32 s94, s56, 28672
    v_or_b32 v151, s98, v6
    s_mul_i32 s99, s56, 24576
    s_lshl_b32 s98, s54, 6
    s_add_u32 s99, s99, s98
    v_and_b32 v149, 31, v0
    v_lshlrev_b32 v149, 1, v149
    s_lshl_b32 s95, s68, 6
    s_lshl_b32 s101, s97, 6
    v_mov_b32 v110, 0
    s_bfe_u32 s80, s2, 0x20003
    s_and_b32 s81, s2, 7
    s_lshl2_add_u32 s80, s81, s80
    s_lshr_b32 s81, s2, 5
    s_lshl4_add_u32 s55, s53, s54
    s_lshl2_add_u32 s55, s55, s52
    s_lshl_b32 s55, s55, 7
    s_add_u32 s55, s55, 17825792
    s_lshl3_add_u32 s90, s80, s81
    s_lshl2_add_u32 s90, s90, s52
    s_lshl_b32 s90, s90, 7
    s_add_u32 s90, s90, 18087936
    s_lshl_b32 s100, s81, 7
    s_mov_b32 s34, 1835008
    s_mov_b32 s35, 0x20000
    s_mov_b32 s38, 524288
    s_mov_b32 s39, 0x20000
    s_mov_b32 s46, 2097152
    s_mov_b32 s47, 0x20000
    s_mov_b32 s50, 256
    s_mov_b32 s51, 0x20000
    v_lshrrev_b32 v97, 1, v0
    v_lshlrev_b32 v97, 7, v97
    v_min_u32 v97, 3456, v97
    v_lshrrev_b32 v96, 3, v0
    v_lshlrev_b32 v96, 7, v96
    s_mov_b32 s72, 0x07060302
    v_bfe_u32 v136, v0, 1, 3
    v_lshrrev_b32 v137, 5, v0
    v_xor_b32 v136, v136, v137
    v_lshlrev_b32 v136, 4, v136
    v_and_b32 v137, 31, v0
    v_lshl_add_u32 v136, v137, 7, v136
    v_add_u32 v136, s60, v136
    s_lshl_b32 s96, s52, 5
    s_add_u32 s96, s96, 0x10000
    v_xor_b32 v22, s96, v136
    v_xor_b32 v23, 32, v22
    v_xor_b32 v24, 64, v22
    v_xor_b32 v25, 96, v22
    v_lshrrev_b32 v136, 5, v0
    v_mul_u32_u24 v30, 1024, v136
    v_bfe_u32 v136, v0, 2, 2
    v_lshl_add_u32 v30, v136, 7, v30
    v_bfe_u32 v136, v0, 4, 1
    v_lshl_add_u32 v30, v136, 5, v30
    v_and_b32 v136, 3, v0
    v_lshl_add_u32 v30, v136, 3, v30
    v_bfe_u32 v136, v0, 3, 1
    v_lshl_add_u32 v30, v136, 6, v30
    v_or_b32 v30, s61, v30
    v_xor_b32 v31, 2048, v30
    v_xor_b32 v32, 4096, v30
    v_xor_b32 v33, 6144, v30
    v_xor_b32 v34, 64, v30
    v_xor_b32 v35, 64, v31
    v_xor_b32 v36, 64, v32
    v_xor_b32 v37, 64, v33
    s_bitcmp1_b32 s54, 0
    s_cbranch_scc1 L_Y
    s_lshl_b32 s73, s56, 9
    s_add_u32 s73, s73, 16777216
    v_lshrrev_b32 v137, 3, v0
    v_bfe_u32 v136, v0, 4, 1
    v_lshlrev_b32 v136, 2, v136
    v_and_b32 v10, 7, v0
    v_xor_b32 v136, v136, v10
    v_lshlrev_b32 v136, 4, v136
    v_mul_u32_u24 v10, 3584, v137
    v_add_u32 v10, v10, v136
    v_add_u32 v11, 27648, v10
    v_add_u32 v12, 27648, v11
    v_add_u32 v13, 27648, v12
    v_lshl_add_u32 v18, v137, 10, v136
    v_add_u32 v19, 7168, v18
    v_add_u32 v20, 7168, v19
    v_add_u32 v21, 7168, v20
    s_lshl_b32 s62, s52, 13
    s_xor_b32 s59, s52, s74
    s_lshl_b32 s63, s68, 6
    s_lshl_b32 s64, s54, 6
    v_add_u32 v8, 23552, v7
    v_add_u32 v9, 23552, v8
    s_mul_i32 s65, s52, 2
    s_add_u32 s65, s65, 0
    s_xor_b32 s65, s65, s74
    s_mul_i32 s65, s65, 229376
    s_lshl_b32 s96, s69, 6
    s_add_u32 s65, s65, s96
    s_mul_i32 s66, s52, 2
    s_add_u32 s66, s66, 1
    s_xor_b32 s66, s66, s74
    s_mul_i32 s66, s66, 229376
    s_lshl_b32 s96, s69, 6
    s_add_u32 s66, s66, s96
    v_lshrrev_b32 v137, 2, v0
    v_mul_u32_u24 v14, 3584, v137
    v_and_b32 v136, 3, v0
    v_lshl_add_u32 v14, v136, 4, v14
    s_waitcnt vmcnt(6)
    v_add_u32 v109, 0x9e3779b9, v109
    v_max_u32 v109, 1, v109
    s_mov_b64 exec, 1
    buffer_store_dword v109, v108, s[48:51], 0 offen sc1
    buffer_store_dword v109, v108, s[20:23], s79 offen sc1
    s_mov_b64 exec, -1
    v_and_b32 v108, 0x1f0, v1
    buffer_load_dwordx4 v[232:235], v1, s[28:31], 0 offen
    buffer_load_dword a255, v148, s[16:19], s94 offen
    buffer_load_dword a254, v151, s[12:15], s99 offen
    buffer_load_ushort v54, v149, s[24:27], s95 offen
    buffer_load_ushort v55, v149, s[24:27], s95 offen offset:64
    buffer_load_ushort v56, v149, s[24:27], s101 offen
    buffer_load_ushort v57, v149, s[24:27], s101 offen offset:64
    buffer_load_dword a253, v110, s[20:23], s55 offen
    buffer_load_dword a252, v110, s[20:23], s90 offen
    buffer_load_dword a251, v110, s[40:43], s100 offen
    s_waitcnt lgkmcnt(0)
    s_barrier
    ds_read_b128 a[0:3], v22 offset:0
    ds_read_b64_tr_b16 a[128:129], v30 offset:0
    ds_read_b64_tr_b16 a[130:131], v30 offset:512
    ds_read_b64_tr_b16 a[132:133], v34 offset:0
    ds_read_b64_tr_b16 a[134:135], v34 offset:512
    ds_read_b128 a[4:7], v23 offset:0
    ds_read_b64_tr_b16 a[136:137], v31 offset:0
    ds_read_b64_tr_b16 a[138:139], v31 offset:512
    ds_read_b64_tr_b16 a[140:141], v35 offset:0
    ds_read_b64_tr_b16 a[142:143], v35 offset:512
    s_waitcnt lgkmcnt(5)
    v_mfma_f32_32x32x16_bf16 v[160:175], a[128:131], a[0:3], 0
    ds_read_b128 a[8:11], v24 offset:0
    ds_read_b64_tr_b16 a[144:145], v32 offset:0
    ds_read_b64_tr_b16 a[146:147], v32 offset:512
    v_add_u32 v15, 56320, v14
    v_mfma_f32_32x32x16_bf16 v[176:191], a[132:135], a[0:3], 0
    ds_read_b64_tr_b16 a[148:149], v36 offset:0
    ds_read_b64_tr_b16 a[150:151], v36 offset:512
    s_add_u32 m0, s60, 98304
    s_xor_b32 s57, s75, 256
    buffer_load_dwordx4 v2, s[8:11], s57 offen lds
    s_waitcnt lgkmcnt(5)
    v_mfma_f32_32x32x16_bf16 v[160:175], a[136:139], a[4:7], v[160:175]
    ds_read_b128 a[12:15], v25 offset:0
    ds_read_b64_tr_b16 a[152:153], v33 offset:0
    ds_read_b64_tr_b16 a[154:155], v33 offset:512
    buffer_load_dwordx4 v3, s[8:11], s57 offen offset:1024 lds
    v_mfma_f32_32x32x16_bf16 v[176:191], a[140:143], a[4:7], v[176:191]
    ds_read_b64_tr_b16 a[156:157], v37 offset:0
    ds_read_b64_tr_b16 a[158:159], v37 offset:512
    buffer_load_dwordx4 v4, s[8:11], s57 offen offset:2048 lds
    s_waitcnt lgkmcnt(5)
    v_mfma_f32_32x32x16_bf16 v[160:175], a[144:147], a[8:11], v[160:175]
    buffer_load_dwordx4 v5, s[8:11], s57 offen offset:3072 lds
    s_xor_b32 s58, s74, 2
    s_add_u32 m0, s61, 16384
    s_mul_i32 s58, s58, 196608
    buffer_load_dwordx4 v26, s[12:15], s58 offen lds
    buffer_load_dwordx4 v27, s[12:15], s58 offen offset:1024 lds
    buffer_load_dwordx4 v[224:227], v1, s[8:11], s89 offen
    s_waitcnt vmcnt(19)
    s_waitcnt lgkmcnt(0)
    s_barrier
    ds_read_b128 a[16:19], v22 offset:16384
    ds_read_b64_tr_b16 a[128:129], v30 offset:8192
    ds_read_b64_tr_b16 a[130:131], v30 offset:8704
    buffer_load_dwordx4 v[228:231], v1, s[8:11], s89 offen offset:1024
    v_mfma_f32_32x32x16_bf16 v[176:191], a[148:151], a[8:11], v[176:191]
    ds_read_b64_tr_b16 a[132:133], v34 offset:8192
    ds_read_b64_tr_b16 a[134:135], v34 offset:8704
    s_add_u32 m0, s60, 114688
    s_xor_b32 s57, s75, 384
    buffer_load_dwordx4 v2, s[8:11], s57 offen lds
    v_mfma_f32_32x32x16_bf16 v[160:175], a[152:155], a[12:15], v[160:175]
    ds_read_b128 a[20:23], v23 offset:16384
    ds_read_b64_tr_b16 a[136:137], v31 offset:8192
    ds_read_b64_tr_b16 a[138:139], v31 offset:8704
    buffer_load_dwordx4 v3, s[8:11], s57 offen offset:1024 lds
    v_mfma_f32_32x32x16_bf16 v[176:191], a[156:159], a[12:15], v[176:191]
    ds_read_b64_tr_b16 a[140:141], v35 offset:8192
    ds_read_b64_tr_b16 a[142:143], v35 offset:8704
    buffer_load_dwordx4 v4, s[8:11], s57 offen offset:2048 lds
    s_waitcnt lgkmcnt(5)
    v_mfma_f32_32x32x16_bf16 v[160:175], a[128:131], a[16:19], v[160:175]
    ds_read_b128 a[24:27], v24 offset:16384
    ds_read_b64_tr_b16 a[144:145], v32 offset:8192
    ds_read_b64_tr_b16 a[146:147], v32 offset:8704
    buffer_load_dwordx4 v5, s[8:11], s57 offen offset:3072 lds
    v_mfma_f32_32x32x16_bf16 v[176:191], a[132:135], a[16:19], v[176:191]
    ds_read_b64_tr_b16 a[148:149], v36 offset:8192
    ds_read_b64_tr_b16 a[150:151], v36 offset:8704
    v_add_u32 v16, 56320, v15
    s_waitcnt lgkmcnt(5)
    v_mfma_f32_32x32x16_bf16 v[160:175], a[136:139], a[20:23], v[160:175]
    ds_read_b128 a[28:31], v25 offset:16384
    ds_read_b64_tr_b16 a[152:153], v33 offset:8192
    ds_read_b64_tr_b16 a[154:155], v33 offset:8704
    s_xor_b32 s58, s74, 3
    s_add_u32 m0, s61, 24576
    s_mul_i32 s58, s58, 196608
    buffer_load_dwordx4 v26, s[12:15], s58 offen lds
    v_mfma_f32_32x32x16_bf16 v[176:191], a[140:143], a[20:23], v[176:191]
    ds_read_b64_tr_b16 a[156:157], v37 offset:8192
    ds_read_b64_tr_b16 a[158:159], v37 offset:8704
    buffer_load_dwordx4 v27, s[12:15], s58 offen offset:1024 lds
    s_waitcnt lgkmcnt(5)
    v_mfma_f32_32x32x16_bf16 v[160:175], a[144:147], a[24:27], v[160:175]
    s_add_u32 m0, s60, 65536
    s_xor_b32 s57, s75, 512
    buffer_load_dwordx4 v2, s[8:11], s57 offen lds
    buffer_load_dwordx4 v3, s[8:11], s57 offen offset:1024 lds
    buffer_load_dwordx4 v4, s[8:11], s57 offen offset:2048 lds
    buffer_load_dwordx4 v5, s[8:11], s57 offen offset:3072 lds
    s_waitcnt vmcnt(12)
    s_waitcnt lgkmcnt(0)
    s_barrier
    ds_read_b128 a[32:35], v22 offset:32768
    ds_read_b64_tr_b16 a[128:129], v30 offset:16384
    ds_read_b64_tr_b16 a[130:131], v30 offset:16896
    s_xor_b32 s58, s74, 4
    s_add_u32 m0, s61, 0
    s_mul_i32 s58, s58, 196608
    buffer_load_dwordx4 v26, s[12:15], s58 offen lds
    v_add_u32 v17, 56320, v16
    s_and_b32 s96, s80, 4
    s_add_u32 s96, s96, s52
    v_mfma_f32_32x32x16_bf16 v[176:191], a[148:151], a[24:27], v[176:191]
    ds_read_b64_tr_b16 a[132:133], v34 offset:16384
    ds_read_b64_tr_b16 a[134:135], v34 offset:16896
    buffer_load_dwordx4 v27, s[12:15], s58 offen offset:1024 lds
    s_mul_i32 s3, s96, 229376
    s_lshl_b32 s96, s81, 7
    s_add_u32 s3, s3, s96
    s_lshl_b32 s87, s52, 17
    s_add_u32 s87, s87, s96
    v_lshrrev_b32 v136, 5, v0
    v_mfma_f32_32x32x16_bf16 v[160:175], a[152:155], a[28:31], v[160:175]
    ds_read_b128 a[36:39], v23 offset:32768
    ds_read_b64_tr_b16 a[136:137], v31 offset:16384
    ds_read_b64_tr_b16 a[138:139], v31 offset:16896
    s_add_u32 m0, s60, 81920
    s_xor_b32 s57, s75, 640
    buffer_load_dwordx4 v2, s[8:11], s57 offen lds
    v_mul_u32_u24 v46, 512, v136
    v_bfe_u32 v136, v0, 2, 2
    v_lshl_add_u32 v46, v136, 6, v46
    v_bfe_u32 v136, v0, 4, 1
    v_mfma_f32_32x32x16_bf16 v[176:191], a[156:159], a[28:31], v[176:191]
    ds_read_b64_tr_b16 a[140:141], v35 offset:16384
    ds_read_b64_tr_b16 a[142:143], v35 offset:16896
    buffer_load_dwordx4 v3, s[8:11], s57 offen offset:1024 lds
    v_lshl_add_u32 v46, v136, 5, v46
    v_and_b32 v136, 3, v0
    v_lshl_add_u32 v46, v136, 3, v46
    s_lshl_b32 s96, s52, 10
    s_add_u32 s96, s96, 0x20000
    v_or_b32 v46, s96, v46
    s_waitcnt lgkmcnt(5)
    v_mfma_f32_32x32x16_bf16 v[160:175], a[128:131], a[32:35], v[160:175]
    ds_read_b128 a[40:43], v24 offset:32768
    ds_read_b64_tr_b16 a[144:145], v32 offset:16384
    ds_read_b64_tr_b16 a[146:147], v32 offset:16896
    buffer_load_dword v109, v110, s[48:51], 0 offen sc1
    v_xor_b32 v47, 1024, v46
    v_xor_b32 v48, 2048, v46
    v_xor_b32 v49, 3072, v46
    v_lshrrev_b32 v136, 5, v0
    v_mul_u32_u24 v100, 512, v136
    v_bfe_u32 v136, v0, 2, 2
    v_mfma_f32_32x32x16_bf16 v[176:191], a[132:135], a[32:35], v[176:191]
    ds_read_b64_tr_b16 a[148:149], v36 offset:16384
    ds_read_b64_tr_b16 a[150:151], v36 offset:16896
    buffer_load_dwordx4 v4, s[8:11], s57 offen offset:2048 lds
    v_lshl_add_u32 v100, v136, 7, v100
    v_bfe_u32 v136, v0, 4, 1
    v_lshl_add_u32 v100, v136, 5, v100
    v_and_b32 v136, 3, v0
    v_lshl_add_u32 v100, v136, 3, v100
    v_bfe_u32 v136, v0, 3, 1
    s_waitcnt lgkmcnt(5)
    v_mfma_f32_32x32x16_bf16 v[160:175], a[136:139], a[36:39], v[160:175]
    ds_read_b128 a[44:47], v25 offset:32768
    ds_read_b64_tr_b16 a[152:153], v33 offset:16384
    ds_read_b64_tr_b16 a[154:155], v33 offset:16896
    buffer_load_dwordx4 v5, s[8:11], s57 offen offset:3072 lds
    v_mov_b32 v242, 0x3f803f80
    v_mov_b32 v236, 0
    v_mov_b32 v237, 0
    v_mov_b32 v238, 0
    v_mov_b32 v239, 0
    v_mov_b32 v240, 0
    v_mfma_f32_32x32x16_bf16 v[176:191], a[140:143], a[36:39], v[176:191]
    ds_read_b64_tr_b16 a[156:157], v37 offset:16384
    ds_read_b64_tr_b16 a[158:159], v37 offset:16896
    s_xor_b32 s58, s74, 5
    s_add_u32 m0, s61, 8192
    s_mul_i32 s58, s58, 196608
    buffer_load_dwordx4 v26, s[12:15], s58 offen lds
    v_mov_b32 v241, 0
    s_waitcnt vmcnt(19)
    v_dot2_f32_bf16 v236, v224, v242, v236
    v_dot2_f32_bf16 v237, v224, v224, v237
    v_dot2_f32_bf16 v238, v224, v232, v238
    s_waitcnt vmcnt(18)
    v_dot2_f32_bf16 v239, v228, v242, v239
    v_dot2_f32_bf16 v240, v228, v228, v240
    v_dot2_f32_bf16 v241, v228, v232, v241
    v_dot2_f32_bf16 v236, v225, v242, v236
    v_dot2_f32_bf16 v237, v225, v225, v237
    v_dot2_f32_bf16 v238, v225, v233, v238
    v_dot2_f32_bf16 v239, v229, v242, v239
    v_dot2_f32_bf16 v240, v229, v229, v240
    v_dot2_f32_bf16 v241, v229, v233, v241
    v_dot2_f32_bf16 v236, v226, v242, v236
    v_dot2_f32_bf16 v237, v226, v226, v237
    v_dot2_f32_bf16 v238, v226, v234, v238
    v_dot2_f32_bf16 v239, v230, v242, v239
    v_dot2_f32_bf16 v240, v230, v230, v240
    v_dot2_f32_bf16 v241, v230, v234, v241
    v_dot2_f32_bf16 v236, v227, v242, v236
    v_dot2_f32_bf16 v237, v227, v227, v237
    v_dot2_f32_bf16 v238, v227, v235, v238
    v_dot2_f32_bf16 v239, v231, v242, v239
    v_dot2_f32_bf16 v240, v231, v231, v240
    v_dot2_f32_bf16 v241, v231, v235, v241
    s_waitcnt lgkmcnt(5)
    v_mfma_f32_32x32x16_bf16 v[160:175], a[144:147], a[40:43], v[160:175]
    s_waitcnt vmcnt(12)
    s_waitcnt lgkmcnt(0)
    s_barrier
    ds_read_b128 a[48:51], v22 offset:49152
    ds_read_b64_tr_b16 a[128:129], v30 offset:24576
    ds_read_b64_tr_b16 a[130:131], v30 offset:25088
    buffer_load_dwordx4 v27, s[12:15], s58 offen offset:1024 lds
    v_permlane32_swap_b32 v236, v239
    v_permlane32_swap_b32 v237, v240
    v_permlane32_swap_b32 v238, v241
    v_add_f32 v236, v236, v239
    v_add_f32 v237, v237, v240
    v_add_f32 v238, v238, v241
    v_mfma_f32_32x32x16_bf16 v[176:191], a[148:151], a[40:43], v[176:191]
    ds_read_b64_tr_b16 a[132:133], v34 offset:24576
    ds_read_b64_tr_b16 a[134:135], v34 offset:25088
    s_add_u32 m0, s60, 98304
    s_xor_b32 s57, s75, 768
    buffer_load_dwordx4 v2, s[8:11], s57 offen lds
    v_add_f32_dpp v236, v236, v236 quad_perm:[1,0,3,2] row_mask:0xf bank_mask:0xf
    v_add_f32_dpp v237, v237, v237 quad_perm:[1,0,3,2] row_mask:0xf bank_mask:0xf
    v_add_f32_dpp v238, v238, v238 quad_perm:[1,0,3,2] row_mask:0xf bank_mask:0xf
    v_add_f32_dpp v236, v236, v236 quad_perm:[2,3,0,1] row_mask:0xf bank_mask:0xf
    v_mfma_f32_32x32x16_bf16 v[160:175], a[152:155], a[44:47], v[160:175]
    ds_read_b128 a[52:55], v23 offset:49152
    ds_read_b64_tr_b16 a[136:137], v31 offset:24576
    ds_read_b64_tr_b16 a[138:139], v31 offset:25088
    buffer_load_dwordx4 v3, s[8:11], s57 offen offset:1024 lds
    v_add_f32_dpp v237, v237, v237 quad_perm:[2,3,0,1] row_mask:0xf bank_mask:0xf
    v_add_f32_dpp v238, v238, v238 quad_perm:[2,3,0,1] row_mask:0xf bank_mask:0xf
    v_add_f32_dpp v236, v236, v236 row_half_mirror row_mask:0xf bank_mask:0xf
    v_add_f32_dpp v237, v237, v237 row_half_mirror row_mask:0xf bank_mask:0xf
    v_add_f32_dpp v238, v238, v238 row_half_mirror row_mask:0xf bank_mask:0xf
    v_add_f32_dpp v236, v236, v236 row_mirror row_mask:0xf bank_mask:0xf
    v_mfma_f32_32x32x16_bf16 v[176:191], a[156:159], a[44:47], v[176:191]
    ds_read_b64_tr_b16 a[140:141], v35 offset:24576
    ds_read_b64_tr_b16 a[142:143], v35 offset:25088
    buffer_load_dwordx4 v4, s[8:11], s57 offen offset:2048 lds
    v_add_f32_dpp v237, v237, v237 row_mirror row_mask:0xf bank_mask:0xf
    v_add_f32_dpp v238, v238, v238 row_mirror row_mask:0xf bank_mask:0xf
    v_mov_b32 v239, v236
    v_mov_b32 v240, v237
    v_mov_b32 v241, v238
    v_permlane16_swap_b32 v236, v239
    s_waitcnt lgkmcnt(5)
    v_mfma_f32_32x32x16_bf16 v[160:175], a[128:131], a[48:51], v[160:175]
    ds_read_b128 a[56:59], v24 offset:49152
    ds_read_b64_tr_b16 a[144:145], v32 offset:24576
    ds_read_b64_tr_b16 a[146:147], v32 offset:25088
    buffer_load_dwordx4 v5, s[8:11], s57 offen offset:3072 lds
    v_permlane16_swap_b32 v237, v240
    v_permlane16_swap_b32 v238, v241
    v_add_f32 v236, v236, v239
    v_add_f32 v237, v237, v240
    v_add_f32 v238, v238, v241
    v_mul_f32 v238, 0x3fb8aa3b, v238
    v_mfma_f32_32x32x16_bf16 v[176:191], a[132:135], a[48:51], v[176:191]
    ds_read_b64_tr_b16 a[148:149], v36 offset:24576
    ds_read_b64_tr_b16 a[150:151], v36 offset:25088
    s_xor_b32 s58, s74, 6
    s_add_u32 m0, s61, 16384
    s_mul_i32 s58, s58, 196608
    buffer_load_dwordx4 v26, s[12:15], s58 offen lds
    v_mul_f32 v244, 0xbb000000, v236
    v_min_f32 v238, 0x42b40000, v238
    v_mul_f32 v245, 0x3b000000, v237
    s_waitcnt lgkmcnt(5)
    v_mfma_f32_32x32x16_bf16 v[160:175], a[136:139], a[52:55], v[160:175]
    ds_read_b128 a[60:63], v25 offset:49152
    ds_read_b64_tr_b16 a[152:153], v33 offset:24576
    ds_read_b64_tr_b16 a[154:155], v33 offset:25088
    buffer_load_dwordx4 v27, s[12:15], s58 offen offset:1024 lds
    v_exp_f32 v246, v238
    v_fma_f32 v245, -v244, v244, v245
    v_max_f32 v245, 0, v245
    v_add_f32 v245, 0x3727c5ac, v245
    v_lshrrev_b32 v239, 5, v0
    v_mfma_f32_32x32x16_bf16 v[176:191], a[140:143], a[52:55], v[176:191]
    ds_read_b64_tr_b16 a[156:157], v37 offset:24576
    ds_read_b64_tr_b16 a[158:159], v37 offset:25088
    s_xor_b32 s58, s59, 0
    s_mul_i32 s58, s58, 196608
    s_add_u32 m0, s62, 0
    s_add_u32 s58, s58, s64
    buffer_load_dwordx4 v6, s[12:15], s58 offen lds
    v_lshlrev_b32 v239, 4, v239
    v_lshl_add_u32 v100, v136, 6, v100
    s_waitcnt lgkmcnt(5)
    v_mfma_f32_32x32x16_bf16 v[160:175], a[144:147], a[56:59], v[160:175]
    s_waitcnt vmcnt(14)
    s_waitcnt lgkmcnt(0)
    s_barrier
    ds_read_b128 a[64:67], v22 offset:0
    ds_read_b64_tr_b16 a[128:129], v30 offset:0
    ds_read_b64_tr_b16 a[130:131], v30 offset:512
    buffer_load_dwordx4 v7, s[12:15], s58 offen offset:1024 lds
    s_and_b32 s96, s52, 1
    s_lshl_b32 s96, s96, 6
    s_add_u32 s96, s96, s60
    v_xor_b32 v100, s96, v100
    v_xor_b32 v101, 64, v100
    v_add_u32 v102, 0x10000, v100
    v_mfma_f32_32x32x16_bf16 v[176:191], a[148:151], a[56:59], v[176:191]
    ds_read_b64_tr_b16 a[132:133], v34 offset:0
    ds_read_b64_tr_b16 a[134:135], v34 offset:512
    buffer_load_dwordx4 v8, s[12:15], s58 offen offset:2048 lds
    v_add_u32 v103, 0x10000, v101
    v_add_u32 v104, 0x10000, v102
    v_add_u32 v105, 0x10000, v103
    v_and_b32 v89, 0x1f0, v1
    v_add_u32 v89, 0, v89
    s_lshl_b32 s96, s52, 2
    s_waitcnt vmcnt(13)
    v_cmp_eq_u32 vcc, 0, v109
    s_nop 0
    s_cbranch_vccnz L_EPX_S
L_EPX_R:
    v_mfma_f32_32x32x16_bf16 v[160:175], a[152:155], a[60:63], v[160:175]
    ds_read_b128 a[68:71], v23 offset:0
    ds_read_b64_tr_b16 a[136:137], v31 offset:0
    ds_read_b64_tr_b16 a[138:139], v31 offset:512
    buffer_load_dwordx4 v9, s[12:15], s58 offen offset:3072 lds
    v_mov_b32 v247, v109
    v_mfma_f32_32x32x16_bf16 v[176:191], a[156:159], a[60:63], v[176:191]
    ds_read_b64_tr_b16 a[140:141], v35 offset:0
    ds_read_b64_tr_b16 a[142:143], v35 offset:512
    s_lshl_b32 s100, s54, 5
    s_add_u32 s100, s100, s73
    s_mov_b32 exec_lo, 1
    s_mov_b32 exec_hi, 1
    buffer_store_dwordx4 v[244:247], v239, s[20:23], s100 offen sc1
    s_mov_b64 exec, -1
    v_add_u32 v88, s96, v89
    s_waitcnt lgkmcnt(5)
    v_mfma_f32_32x32x16_bf16 v[160:175], a[128:131], a[64:67], v[160:175]
    ds_read_b128 a[72:75], v24 offset:0
    ds_read_b64_tr_b16 a[144:145], v32 offset:0
    ds_read_b64_tr_b16 a[146:147], v32 offset:512
    s_add_u32 m0, s62, 4096
    s_add_u32 s58, s58, 98304
    buffer_load_dwordx4 v6, s[12:15], s58 offen lds
    s_and_b32 s96, s54, 14
    s_lshl_b32 s96, s96, 6
    s_add_u32 s96, s96, s56
    s_lshl_b32 s70, s96, 12
    v_mfma_f32_32x32x16_bf16 v[176:191], a[132:135], a[64:67], v[176:191]
    ds_read_b64_tr_b16 a[148:149], v36 offset:0
    ds_read_b64_tr_b16 a[150:151], v36 offset:512
    buffer_load_dwordx4 v7, s[12:15], s58 offen offset:1024 lds
    s_add_u32 s76, s70, 262144
    s_mul_i32 s71, s56, 147456
    s_add_u32 s71, s71, 6291456
    s_mov_b32 s78, 17825792
    v_lshrrev_b32 v136, 2, v0
    v_xor_b32 v136, v136, v0
    s_waitcnt lgkmcnt(5)
    v_mfma_f32_32x32x16_bf16 v[160:175], a[136:139], a[68:71], v[160:175]
    ds_read_b128 a[76:79], v25 offset:0
    ds_read_b64_tr_b16 a[152:153], v33 offset:0
    ds_read_b64_tr_b16 a[154:155], v33 offset:512
    buffer_load_dwordx4 v8, s[12:15], s58 offen offset:2048 lds
    v_bfe_i32 v136, v136, 2, 1
    v_not_b32 v136, v136
    v_and_b32 v50, 0x3f803f80, v136
    v_and_b32 v51, 0x3f803f80, v136
    v_and_b32 v52, 0x3f803f80, v136
    v_and_b32 v53, 0x3f803f80, v136
    v_mfma_f32_32x32x16_bf16 v[176:191], a[140:143], a[68:71], v[176:191]
    ds_read_b64_tr_b16 a[156:157], v37 offset:0
    ds_read_b64_tr_b16 a[158:159], v37 offset:512
    buffer_load_dwordx4 v9, s[12:15], s58 offen offset:3072 lds
    v_and_b32 v38, 0xffff, v30
    v_and_b32 v39, 0xffff, v31
    v_and_b32 v40, 0xffff, v32
    v_and_b32 v41, 0xffff, v33
    v_and_b32 v42, 0xffff, v34
    v_and_b32 v43, 0xffff, v35
    s_waitcnt lgkmcnt(5)
    v_mfma_f32_32x32x16_bf16 v[160:175], a[144:147], a[72:75], v[160:175]
    s_waitcnt vmcnt(15)
    s_waitcnt lgkmcnt(0)
    s_barrier
    ds_read_b128 a[80:83], v22 offset:16384
    ds_read_b64_tr_b16 a[128:129], v30 offset:8192
    ds_read_b64_tr_b16 a[130:131], v30 offset:8704
    s_add_u32 m0, s60, 114688
    s_xor_b32 s57, s75, 896
    buffer_load_dwordx4 v2, s[8:11], s57 offen lds
    v_and_b32 v44, 0xffff, v36
    v_and_b32 v45, 0xffff, v37
    s_and_b32 s96, s54, 14
    s_lshl4_add_u32 s96, s53, s96
    v_mfma_f32_32x32x16_bf16 v[176:191], a[148:151], a[72:75], v[176:191]
    ds_read_b64_tr_b16 a[132:133], v34 offset:8192
    ds_read_b64_tr_b16 a[134:135], v34 offset:8704
    buffer_load_dwordx4 v3, s[8:11], s57 offen offset:1024 lds
    s_lshl2_add_u32 s96, s96, s52
    s_lshl_b32 s96, s96, 7
    s_and_b32 s97, s54, 1
    s_lshl2_add_u32 s96, s97, s96
    v_lshrrev_b32 v141, 1, v0
    v_mul_u32_u24 v141, 8200, v141
    v_mfma_f32_32x32x16_bf16 v[160:175], a[152:155], a[76:79], v[160:175]
    ds_read_b128 a[84:87], v23 offset:16384
    ds_read_b64_tr_b16 a[136:137], v31 offset:8192
    ds_read_b64_tr_b16 a[138:139], v31 offset:8704
    buffer_load_dwordx4 v4, s[8:11], s57 offen offset:2048 lds
    v_and_b32 v142, 1, v0
    v_lshl_add_u32 v141, v142, 9, v141
    v_add_u32 v106, s96, v141
    s_lshr_b32 s96, s56, 1
    s_lshl_b32 s96, s96, 5
    s_lshr_b32 s97, s54, 2
    v_mfma_f32_32x32x16_bf16 v[176:191], a[156:159], a[76:79], v[176:191]
    ds_read_b64_tr_b16 a[140:141], v35 offset:8192
    ds_read_b64_tr_b16 a[142:143], v35 offset:8704
    buffer_load_dwordx4 v5, s[8:11], s57 offen offset:3072 lds
    s_add_u32 s96, s96, s97
    s_lshl_b32 s96, s96, 4
    s_and_b32 s97, s54, 3
    s_add_u32 s96, s96, s97
    s_and_b32 s97, s52, 1
    s_lshl1_add_u32 s96, s96, s97
    s_waitcnt lgkmcnt(5)
    v_mfma_f32_32x32x16_bf16 v[160:175], a[128:131], a[80:83], v[160:175]
    ds_read_b128 a[88:91], v24 offset:16384
    ds_read_b64_tr_b16 a[144:145], v32 offset:8192
    ds_read_b64_tr_b16 a[146:147], v32 offset:8704
    s_xor_b32 s58, s74, 7
    s_add_u32 m0, s61, 24576
    s_mul_i32 s58, s58, 196608
    buffer_load_dwordx4 v26, s[12:15], s58 offen lds
    s_lshl_b32 s96, s96, 2
    s_add_u32 s96, s96, 262144
    v_lshl_add_u32 v107, v0, 9, s96
    v_mfma_f32_32x32x16_bf16 v[176:191], a[132:135], a[80:83], v[176:191]
    ds_read_b64_tr_b16 a[148:149], v36 offset:8192
    ds_read_b64_tr_b16 a[150:151], v36 offset:8704
    buffer_load_dwordx4 v27, s[12:15], s58 offen offset:1024 lds
    s_lshr_b32 s96, s56, 1
    s_andn2_b32 s96, s96, 4
    s_lshr_b32 s97, s54, 3
    s_lshl2_add_u32 s96, s97, s96
    s_lshl_b32 s96, s96, 5
    s_bfe_u32 s97, s54, 0x20001
    s_waitcnt lgkmcnt(5)
    v_mfma_f32_32x32x16_bf16 v[160:175], a[136:139], a[84:87], v[160:175]
    ds_read_b128 a[92:95], v25 offset:16384
    ds_read_b64_tr_b16 a[152:153], v33 offset:8192
    ds_read_b64_tr_b16 a[154:155], v33 offset:8704
    s_add_u32 s96, s96, s97
    s_bfe_u32 s97, s56, 0x10003
    s_lshl3_add_u32 s96, s96, s97
    s_and_b32 s97, s54, 1
    s_lshl1_add_u32 s96, s96, s97
    s_and_b32 s97, s52, 1
    s_lshl1_add_u32 s96, s96, s97
    v_mfma_f32_32x32x16_bf16 v[176:191], a[140:143], a[84:87], v[176:191]
    ds_read_b64_tr_b16 a[156:157], v37 offset:8192
    ds_read_b64_tr_b16 a[158:159], v37 offset:8704
    s_lshl_b32 s96, s96, 2
    s_add_u32 s96, s96, 262144
    v_lshl_add_u32 v87, v0, 9, s96
    s_lshl_b32 s96, s54, 6
    s_add_u32 s96, s96, s56
    s_or_b32 s77, s96, 64
    s_lshl_b32 s77, s77, 11
    s_waitcnt lgkmcnt(5)
    v_mfma_f32_32x32x16_bf16 v[160:175], a[144:147], a[88:91], v[160:175]
    s_waitcnt vmcnt(6)
    s_waitcnt lgkmcnt(0)
    s_barrier
    ds_read_b128 a[96:99], v22 offset:32768
    ds_read_b64_tr_b16 a[128:129], v30 offset:16384
    ds_read_b64_tr_b16 a[130:131], v30 offset:16896
    ds_read_b64_tr_b16 a[132:133], v34 offset:16384
    ds_read_b64_tr_b16 a[134:135], v34 offset:16896
    s_add_u32 s77, s77, 4194304
    s_lshl_b32 s93, s96, 12
    s_sub_u32 s92, s93, 16384
    s_sub_u32 s91, s93, 32768
    s_cmp_lt_u32 s53, 1
    s_cselect_b32 s92, 0, s92
    s_cselect_b32 s96, 0x40000000, 0
    v_mfma_f32_32x32x16_bf16 v[176:191], a[148:151], a[88:91], v[176:191]
    ds_read_b64_tr_b16 a[160:161], v38 offset:0
    ds_read_b64_tr_b16 a[162:163], v38 offset:512
    ds_read_b64_tr_b16 a[164:165], v42 offset:0
    ds_read_b64_tr_b16 a[166:167], v42 offset:512
    v_or_b32 v91, s96, v1
    s_cmp_lt_u32 s53, 2
    s_cselect_b32 s91, 0, s91
    s_cselect_b32 s96, 0x40000000, 0
    v_or_b32 v92, s96, v1
    v_mfma_f32_32x32x16_bf16 v[160:175], a[152:155], a[92:95], v[160:175]
    ds_read_b128 a[100:103], v23 offset:32768
    ds_read_b64_tr_b16 a[136:137], v31 offset:16384
    ds_read_b64_tr_b16 a[138:139], v31 offset:16896
    ds_read_b64_tr_b16 a[140:141], v35 offset:16384
    ds_read_b64_tr_b16 a[142:143], v35 offset:16896
    s_mul_i32 s83, s52, 4128
    s_add_u32 s83, s83, 2048
    v_lshrrev_b32 v141, 3, v0
    v_min_u32 v141, 2, v141
    v_add_u32 v142, s53, v141
    v_mfma_f32_32x32x16_bf16 v[176:191], a[156:159], a[92:95], v[176:191]
    ds_read_b64_tr_b16 a[168:169], v39 offset:0
    ds_read_b64_tr_b16 a[170:171], v39 offset:512
    ds_read_b64_tr_b16 a[172:173], v43 offset:0
    ds_read_b64_tr_b16 a[174:175], v43 offset:512
    v_cmp_le_u32 vcc, 2, v142
    v_mov_b32 v99, 0x3f803f80
    s_nop 0
    v_cndmask_b32 v99, 0, v99, vcc
    v_mul_u32_u24 v98, 16512, v141
    s_waitcnt lgkmcnt(9)
    v_mfma_f32_32x32x16_bf16 v[160:175], a[128:131], a[96:99], v[160:175]
    ds_read_b128 a[104:107], v24 offset:32768
    ds_read_b64_tr_b16 a[144:145], v32 offset:16384
    ds_read_b64_tr_b16 a[146:147], v32 offset:16896
    s_xor_b32 s58, s59, 4
    s_mul_i32 s58, s58, 196608
    s_add_u32 m0, s62, 32768
    s_add_u32 s58, s58, s64
    buffer_load_dwordx4 v6, s[12:15], s58 offen lds
    v_mfma_f32_32x32x16_bf16 v[176:191], a[132:135], a[96:99], v[176:191]
    ds_read_b64_tr_b16 a[148:149], v36 offset:16384
    ds_read_b64_tr_b16 a[150:151], v36 offset:16896
    ds_read_b64_tr_b16 a[176:177], v40 offset:0
    buffer_load_dwordx4 v7, s[12:15], s58 offen offset:1024 lds
    v_bfe_u32 v141, v0, 2, 1
    v_mfma_f32_32x32x16_bf16 v[192:207], a[160:163], a[0:3], 0
    ds_read_b64_tr_b16 a[178:179], v40 offset:512
    ds_read_b64_tr_b16 a[180:181], v44 offset:0
    ds_read_b64_tr_b16 a[182:183], v44 offset:512
    v_mul_u32_u24 v141, 1040, v141
    v_and_b32 v142, 3, v0
    v_mfma_f32_32x32x16_bf16 v[208:223], a[164:167], a[0:3], 0
    buffer_load_dwordx4 v8, s[12:15], s58 offen offset:2048 lds
    v_lshl_add_u32 v141, v142, 2, v141
    v_add3_u32 v98, v98, v141, s83
    v_add_u32 v93, s83, v1
    s_waitcnt lgkmcnt(9)
    v_mfma_f32_32x32x16_bf16 v[160:175], a[136:139], a[100:103], v[160:175]
    ds_read_b128 a[108:111], v25 offset:32768
    ds_read_b64_tr_b16 a[152:153], v33 offset:16384
    ds_read_b64_tr_b16 a[154:155], v33 offset:16896
    buffer_load_dwordx4 v9, s[12:15], s58 offen offset:3072 lds
    v_and_b32 v141, 0x2f0, v1
    v_mfma_f32_32x32x16_bf16 v[176:191], a[140:143], a[100:103], v[176:191]
    ds_read_b64_tr_b16 a[156:157], v37 offset:16384
    ds_read_b64_tr_b16 a[158:159], v37 offset:16896
    ds_read_b64_tr_b16 a[184:185], v41 offset:0
    v_add_u32 v142, 256, v141
    v_and_b32 v94, 16, v0
    v_mfma_f32_32x32x16_bf16 v[192:207], a[168:171], a[4:7], v[192:207]
    ds_read_b64_tr_b16 a[186:187], v41 offset:512
    ds_read_b64_tr_b16 a[188:189], v45 offset:0
    ds_read_b64_tr_b16 a[190:191], v45 offset:512
    s_add_u32 m0, s62, 36864
    s_add_u32 s58, s58, 98304
    buffer_load_dwordx4 v6, s[12:15], s58 offen lds
    v_mfma_f32_32x32x16_bf16 v[208:223], a[172:175], a[4:7], v[208:223]
    v_cmp_eq_u32 vcc, 0, v94
    v_mov_b32 v94, 1024
    s_add_u32 s96, s83, 2048
    v_cndmask_b32 v141, v94, v141, vcc
    v_cndmask_b32 v142, v94, v142, vcc
    s_waitcnt lgkmcnt(9)
    v_mfma_f32_32x32x16_bf16 v[160:175], a[144:147], a[104:107], v[160:175]
    s_waitcnt vmcnt(5)
    s_waitcnt lgkmcnt(0)
    s_barrier
    ds_read_b128 a[112:115], v22 offset:49152
    ds_read_b64_tr_b16 a[128:129], v30 offset:24576
    ds_read_b64_tr_b16 a[130:131], v30 offset:25088
    buffer_load_dwordx4 v7, s[12:15], s58 offen offset:1024 lds
    v_add_u32 v94, s96, v141
    v_mfma_f32_32x32x16_bf16 v[176:191], a[148:151], a[104:107], v[176:191]
    ds_read_b64_tr_b16 a[132:133], v34 offset:24576
    ds_read_b64_tr_b16 a[134:135], v34 offset:25088
    ds_read_b64_tr_b16 a[160:161], v38 offset:8192
    buffer_load_dwordx4 v8, s[12:15], s58 offen offset:2048 lds
    v_add_u32 v95, s96, v142
    v_mfma_f32_32x32x16_bf16 v[192:207], a[176:179], a[8:11], v[192:207]
    ds_read_b64_tr_b16 a[162:163], v38 offset:8704
    ds_read_b64_tr_b16 a[164:165], v42 offset:8192
    ds_read_b64_tr_b16 a[166:167], v42 offset:8704
    s_mul_i32 s84, s80, 294912
    s_add_u32 s84, s84, 6291456
    v_mfma_f32_32x32x16_bf16 v[208:223], a[180:183], a[8:11], v[208:223]
    buffer_load_dwordx4 v9, s[12:15], s58 offen offset:3072 lds
    s_add_u32 s85, s84, 147456
    s_cmp_lt_u32 s52, 2
    s_cselect_b32 s96, s84, s85
    s_cselect_b32 s85, s85, s84
    v_mfma_f32_32x32x16_bf16 v[160:175], a[152:155], a[108:111], v[160:175]
    ds_read_b128 a[116:119], v23 offset:49152
    ds_read_b64_tr_b16 a[136:137], v31 offset:24576
    ds_read_b64_tr_b16 a[138:139], v31 offset:25088
    s_lshl_b32 s97, s52, 13
    s_add_u32 s86, s96, s97
    v_mfma_f32_32x32x16_bf16 v[176:191], a[156:159], a[108:111], v[176:191]
    ds_read_b64_tr_b16 a[140:141], v35 offset:24576
    ds_read_b64_tr_b16 a[142:143], v35 offset:25088
    ds_read_b64_tr_b16 a[168:169], v39 offset:8192
    s_xor_b32 s58, s59, 0
    s_mul_i32 s58, s58, 229376
    s_add_u32 m0, s62, 65536
    s_add_u32 s58, s58, s63
    buffer_load_dwordx4 v10, s[16:19], s58 offen lds
    v_mfma_f32_32x32x16_bf16 v[192:207], a[184:187], a[12:15], v[192:207]
    ds_read_b64_tr_b16 a[170:171], v39 offset:8704
    ds_read_b64_tr_b16 a[172:173], v43 offset:8192
    ds_read_b64_tr_b16 a[174:175], v43 offset:8704
    buffer_load_dwordx4 v11, s[16:19], s58 offen offset:1024 lds
    s_add_u32 s86, s86, 114688
    v_mfma_f32_32x32x16_bf16 v[208:223], a[188:191], a[12:15], v[208:223]
    s_and_b32 s97, s80, 4
    s_add_u32 s97, s97, s52
    s_mul_i32 s97, s97, 14336
    s_add_u32 s84, s96, s97
    s_waitcnt lgkmcnt(9)
    v_mfma_f32_32x32x16_bf16 v[160:175], a[128:131], a[112:115], v[160:175]
    ds_read_b128 a[120:123], v24 offset:49152
    ds_read_b64_tr_b16 a[144:145], v32 offset:24576
    ds_read_b64_tr_b16 a[146:147], v32 offset:25088
    buffer_load_dwordx4 v12, s[16:19], s58 offen offset:2048 lds
    s_add_u32 s85, s85, s97
    v_mfma_f32_32x32x16_bf16 v[176:191], a[132:135], a[112:115], v[176:191]
    ds_read_b64_tr_b16 a[148:149], v36 offset:24576
    ds_read_b64_tr_b16 a[150:151], v36 offset:25088
    ds_read_b64_tr_b16 a[176:177], v40 offset:8192
    buffer_load_dwordx4 v13, s[16:19], s58 offen offset:3072 lds
    s_and_b32 s88, s52, 1
    v_mfma_f32_32x32x16_bf16 v[192:207], a[160:163], a[16:19], v[192:207]
    ds_read_b64_tr_b16 a[178:179], v40 offset:8704
    ds_read_b64_tr_b16 a[180:181], v44 offset:8192
    ds_read_b64_tr_b16 a[182:183], v44 offset:8704
    s_lshl1_add_u32 s88, s81, s88
    s_lshl_b32 s88, s88, 6
    v_mfma_f32_32x32x16_bf16 v[208:223], a[164:167], a[16:19], v[208:223]
    s_add_u32 m0, s62, 69632
    s_add_u32 s58, s58, 114688
    buffer_load_dwordx4 v10, s[16:19], s58 offen lds
    v_lshrrev_b32 v143, 5, v0
    s_waitcnt lgkmcnt(9)
    v_mfma_f32_32x32x16_bf16 v[160:175], a[136:139], a[116:119], v[160:175]
    ds_read_b128 a[124:127], v25 offset:49152
    ds_read_b64_tr_b16 a[152:153], v33 offset:24576
    ds_read_b64_tr_b16 a[154:155], v33 offset:25088
    v_lshlrev_b32 v143, 2, v143
    v_and_b32 v112, 31, v0
    v_mfma_f32_32x32x16_bf16 v[176:191], a[140:143], a[116:119], v[176:191]
    ds_read_b64_tr_b16 a[156:157], v37 offset:24576
    ds_read_b64_tr_b16 a[158:159], v37 offset:25088
    ds_read_b64_tr_b16 a[184:185], v41 offset:8192
    buffer_load_dwordx4 v11, s[16:19], s58 offen offset:1024 lds
    v_sub_u32 v143, v112, v143
    v_mfma_f32_32x32x16_bf16 v[192:207], a[168:171], a[20:23], v[192:207]
    ds_read_b64_tr_b16 a[186:187], v41 offset:8704
    ds_read_b64_tr_b16 a[188:189], v45 offset:8192
    ds_read_b64_tr_b16 a[190:191], v45 offset:8704
    v_add_u32 v143, 1, v143
    v_med3_i32 v143, v143, 0, 31
    v_mfma_f32_32x32x16_bf16 v[208:223], a[172:175], a[20:23], v[208:223]
    buffer_load_dwordx4 v12, s[16:19], s58 offen offset:2048 lds
    v_lshlrev_b32 v143, v143, -1
    v_bfe_i32 v112, v143, 0, 1
    v_bfe_i32 v113, v143, 1, 1
    s_waitcnt lgkmcnt(9)
    v_mfma_f32_32x32x16_bf16 v[160:175], a[144:147], a[120:123], v[160:175]
    s_waitcnt lgkmcnt(0)
    s_barrier
    ds_read_b64_tr_b16 a[160:161], v38 offset:16384
    ds_read_b64_tr_b16 a[162:163], v38 offset:16896
    ds_read_b64_tr_b16 a[164:165], v42 offset:16384
    buffer_load_dwordx4 v13, s[16:19], s58 offen offset:3072 lds
    v_bfe_i32 v114, v143, 2, 1
    v_mfma_f32_32x32x16_bf16 v[176:191], a[148:151], a[120:123], v[176:191]
    ds_read_b64_tr_b16 a[166:167], v42 offset:16896
    v_bfe_i32 v115, v143, 3, 1
    v_bfe_i32 v116, v143, 8, 1
    v_bfe_i32 v117, v143, 9, 1
    v_bfe_i32 v118, v143, 10, 1
    v_mfma_f32_32x32x16_bf16 v[192:207], a[176:179], a[24:27], v[192:207]
    v_bfe_i32 v119, v143, 11, 1
    v_bfe_i32 v120, v143, 16, 1
    v_bfe_i32 v121, v143, 17, 1
    v_bfe_i32 v122, v143, 18, 1
    v_bfe_i32 v123, v143, 19, 1
    v_mfma_f32_32x32x16_bf16 v[208:223], a[180:183], a[24:27], v[208:223]
    v_bfe_i32 v124, v143, 24, 1
    v_bfe_i32 v125, v143, 25, 1
    v_bfe_i32 v126, v143, 26, 1
    v_bfe_i32 v127, v143, 27, 1
    v_mfma_f32_32x32x16_bf16 v[160:175], a[152:155], a[124:127], v[160:175]
    ds_read_b64_tr_b16 a[168:169], v39 offset:16384
    ds_read_b64_tr_b16 a[170:171], v39 offset:16896
    ds_read_b64_tr_b16 a[172:173], v43 offset:16384
    v_perm_b32 v128, v113, v112, s72
    v_perm_b32 v129, v115, v114, s72
    v_mfma_f32_32x32x16_bf16 v[176:191], a[156:159], a[124:127], v[176:191]
    ds_read_b64_tr_b16 a[174:175], v43 offset:16896
    v_perm_b32 v130, v117, v116, s72
    v_perm_b32 v131, v119, v118, s72
    v_perm_b32 v132, v121, v120, s72
    v_perm_b32 v133, v123, v122, s72
    v_mfma_f32_32x32x16_bf16 v[192:207], a[184:187], a[28:31], v[192:207]
    v_perm_b32 v134, v125, v124, s72
    v_perm_b32 v135, v127, v126, s72
    s_add_u32 s24, s20, s55
    s_addc_u32 s25, s21, 0
    s_add_u32 s26, s20, s90
    s_addc_u32 s27, s21, 0
    v_mfma_f32_32x32x16_bf16 v[208:223], a[188:191], a[28:31], v[208:223]
    v_readfirstlane_b32 s28, v109
    v_readfirstlane_b32 s29, v109
    ds_read_b64_tr_b16 a[176:177], v40 offset:16384
    ds_read_b64_tr_b16 a[178:179], v40 offset:16896
    ds_read_b64_tr_b16 a[180:181], v44 offset:16384
    ds_read_b64_tr_b16 a[182:183], v44 offset:16896
    s_waitcnt lgkmcnt(8)
    v_mfma_f32_32x32x16_bf16 v[192:207], a[160:163], a[32:35], v[192:207]
    ds_read_b64_tr_b16 a[184:185], v41 offset:16384
    ds_read_b64_tr_b16 a[186:187], v41 offset:16896
    v_cvt_pk_bf16_f32 v160, v160, v161
    v_cvt_pk_bf16_f32 v161, v162, v163
    v_cvt_pk_bf16_f32 v162, v164, v165
    v_mfma_f32_32x32x16_bf16 v[208:223], a[164:167], a[32:35], v[208:223]
    ds_read_b64_tr_b16 a[188:189], v45 offset:16384
    ds_read_b64_tr_b16 a[190:191], v45 offset:16896
    v_cvt_pk_bf16_f32 v163, v166, v167
    v_cvt_pk_bf16_f32 v164, v168, v169
    s_waitcnt lgkmcnt(8)
    v_mfma_f32_32x32x16_bf16 v[192:207], a[168:171], a[36:39], v[192:207]
    ds_read_b64_tr_b16 a[160:161], v38 offset:24576
    ds_read_b64_tr_b16 a[162:163], v38 offset:25088
    v_cvt_pk_bf16_f32 v165, v170, v171
    v_cvt_pk_bf16_f32 v166, v172, v173
    v_cvt_pk_bf16_f32 v167, v174, v175
    v_mfma_f32_32x32x16_bf16 v[208:223], a[172:175], a[36:39], v[208:223]
    ds_read_b64_tr_b16 a[164:165], v42 offset:24576
    ds_read_b64_tr_b16 a[166:167], v42 offset:25088
    buffer_store_dwordx4 v[160:163], v1, s[20:23], s70 offen offset:0 sc1
    v_cvt_pk_bf16_f32 v176, v176, v177
    s_waitcnt lgkmcnt(8)
    v_mfma_f32_32x32x16_bf16 v[192:207], a[176:179], a[40:43], v[192:207]
    ds_read_b64_tr_b16 a[168:169], v39 offset:24576
    ds_read_b64_tr_b16 a[170:171], v39 offset:25088
    v_cvt_pk_bf16_f32 v177, v178, v179
    v_cvt_pk_bf16_f32 v178, v180, v181
    v_cvt_pk_bf16_f32 v179, v182, v183
    v_mfma_f32_32x32x16_bf16 v[208:223], a[180:183], a[40:43], v[208:223]
    ds_read_b64_tr_b16 a[172:173], v43 offset:24576
    ds_read_b64_tr_b16 a[174:175], v43 offset:25088
    v_cvt_pk_bf16_f32 v180, v184, v185
    v_cvt_pk_bf16_f32 v181, v186, v187
    s_waitcnt lgkmcnt(8)
    v_mfma_f32_32x32x16_bf16 v[192:207], a[184:187], a[44:47], v[192:207]
    ds_read_b64_tr_b16 a[176:177], v40 offset:24576
    ds_read_b64_tr_b16 a[178:179], v40 offset:25088
    buffer_store_dwordx4 v[164:167], v1, s[20:23], s70 offen offset:1024 sc1
    v_cvt_pk_bf16_f32 v182, v188, v189
    v_cvt_pk_bf16_f32 v183, v190, v191
    v_mfma_f32_32x32x16_bf16 v[208:223], a[188:191], a[44:47], v[208:223]
    ds_read_b64_tr_b16 a[180:181], v44 offset:24576
    ds_read_b64_tr_b16 a[182:183], v44 offset:25088
    v_add_u32 v30, 0x10000, v38
    v_add_u32 v31, 0x10000, v39
    s_waitcnt lgkmcnt(8)
    v_mfma_f32_32x32x16_bf16 v[192:207], a[160:163], a[48:51], v[192:207]
    ds_read_b64_tr_b16 a[184:185], v41 offset:24576
    ds_read_b64_tr_b16 a[186:187], v41 offset:25088
    v_add_u32 v32, 0x10000, v40
    v_add_u32 v33, 0x10000, v41
    v_add_u32 v34, 0x10000, v42
    v_mfma_f32_32x32x16_bf16 v[208:223], a[164:167], a[48:51], v[208:223]
    ds_read_b64_tr_b16 a[188:189], v45 offset:24576
    ds_read_b64_tr_b16 a[190:191], v45 offset:25088
    buffer_store_dwordx4 v[176:179], v1, s[20:23], s76 offen offset:0 sc1
    v_add_u32 v35, 0x10000, v43
    s_waitcnt lgkmcnt(8)
    v_mfma_f32_32x32x16_bf16 v[192:207], a[168:171], a[52:55], v[192:207]
    s_waitcnt vmcnt(11)
    s_waitcnt lgkmcnt(0)
    s_barrier
    ds_read_b64_tr_b16 a[160:161], v38 offset:32768
    ds_read_b64_tr_b16 a[162:163], v38 offset:33280
    v_add_u32 v36, 0x10000, v44
    v_add_u32 v37, 0x10000, v45
    s_mov_b32 s61, 0x6325410
    v_mfma_f32_32x32x16_bf16 v[208:223], a[172:175], a[52:55], v[208:223]
    ds_read_b64_tr_b16 a[164:165], v42 offset:32768
    ds_read_b64_tr_b16 a[166:167], v42 offset:33280
    s_bitcmp1_b32 s52, 0
    s_cselect_b32 s61, 0x0654321, s61
    v_mfma_f32_32x32x16_bf16 v[192:207], a[176:179], a[56:59], v[192:207]
    ds_read_b64_tr_b16 a[168:169], v39 offset:32768
    ds_read_b64_tr_b16 a[170:171], v39 offset:33280
    buffer_store_dwordx4 v[180:183], v1, s[20:23], s76 offen offset:1024 sc1
    s_mov_b32 s75, 1179648
    s_bitcmp1_b32 s80, 2
    s_cselect_b32 s75, 4293787648, s75
    v_mfma_f32_32x32x16_bf16 v[208:223], a[180:183], a[56:59], v[208:223]
    ds_read_b64_tr_b16 a[172:173], v43 offset:32768
    ds_read_b64_tr_b16 a[174:175], v43 offset:33280
    v_mfma_f32_32x32x16_bf16 v[192:207], a[184:187], a[60:63], v[192:207]
    ds_read_b64_tr_b16 a[176:177], v40 offset:32768
    ds_read_b64_tr_b16 a[178:179], v40 offset:33280
    v_mfma_f32_32x32x16_bf16 v[208:223], a[188:191], a[60:63], v[208:223]
    ds_read_b64_tr_b16 a[180:181], v44 offset:32768
    ds_read_b64_tr_b16 a[182:183], v44 offset:33280
    s_xor_b32 s58, s59, 4
    s_mul_i32 s58, s58, 229376
    s_add_u32 m0, s62, 98304
    s_add_u32 s58, s58, s63
    buffer_load_dwordx4 v10, s[16:19], s58 offen lds
    s_waitcnt lgkmcnt(8)
    v_mfma_f32_32x32x16_bf16 v[192:207], a[160:163], a[64:67], v[192:207]
    ds_read_b64_tr_b16 a[184:185], v41 offset:32768
    ds_read_b64_tr_b16 a[186:187], v41 offset:33280
    v_mfma_f32_32x32x16_bf16 v[208:223], a[164:167], a[64:67], v[208:223]
    ds_read_b64_tr_b16 a[188:189], v45 offset:32768
    ds_read_b64_tr_b16 a[190:191], v45 offset:33280
    buffer_load_dwordx4 v11, s[16:19], s58 offen offset:1024 lds
    s_waitcnt lgkmcnt(8)
    v_mfma_f32_32x32x16_bf16 v[192:207], a[168:171], a[68:71], v[192:207]
    ds_read_b64_tr_b16 a[160:161], v38 offset:40960
    ds_read_b64_tr_b16 a[162:163], v38 offset:41472
    v_mfma_f32_32x32x16_bf16 v[208:223], a[172:175], a[68:71], v[208:223]
    ds_read_b64_tr_b16 a[164:165], v42 offset:40960
    ds_read_b64_tr_b16 a[166:167], v42 offset:41472
    buffer_load_dwordx4 v[74:77], v108, s[20:23], s73 offen sc1
    s_waitcnt lgkmcnt(8)
    v_mfma_f32_32x32x16_bf16 v[192:207], a[176:179], a[72:75], v[192:207]
    ds_read_b64_tr_b16 a[168:169], v39 offset:40960
    ds_read_b64_tr_b16 a[170:171], v39 offset:41472
    v_mfma_f32_32x32x16_bf16 v[208:223], a[180:183], a[72:75], v[208:223]
    ds_read_b64_tr_b16 a[172:173], v43 offset:40960
    ds_read_b64_tr_b16 a[174:175], v43 offset:41472
    buffer_load_dwordx4 v12, s[16:19], s58 offen offset:2048 lds
    s_waitcnt lgkmcnt(8)
    v_mfma_f32_32x32x16_bf16 v[192:207], a[184:187], a[76:79], v[192:207]
    ds_read_b64_tr_b16 a[176:177], v40 offset:40960
    ds_read_b64_tr_b16 a[178:179], v40 offset:41472
    v_mfma_f32_32x32x16_bf16 v[208:223], a[188:191], a[76:79], v[208:223]
    ds_read_b64_tr_b16 a[180:181], v44 offset:40960
    ds_read_b64_tr_b16 a[182:183], v44 offset:41472
    buffer_load_dwordx4 v13, s[16:19], s58 offen offset:3072 lds
    s_waitcnt lgkmcnt(8)
    v_mfma_f32_32x32x16_bf16 v[192:207], a[160:163], a[80:83], v[192:207]
    ds_read_b64_tr_b16 a[184:185], v41 offset:40960
    ds_read_b64_tr_b16 a[186:187], v41 offset:41472
    v_mfma_f32_32x32x16_bf16 v[208:223], a[164:167], a[80:83], v[208:223]
    ds_read_b64_tr_b16 a[188:189], v45 offset:40960
    ds_read_b64_tr_b16 a[190:191], v45 offset:41472
    s_add_u32 m0, s62, 102400
    s_add_u32 s58, s58, 114688
    buffer_load_dwordx4 v10, s[16:19], s58 offen lds
    s_waitcnt lgkmcnt(8)
    v_mfma_f32_32x32x16_bf16 v[192:207], a[168:171], a[84:87], v[192:207]
    ds_read_b64_tr_b16 a[160:161], v38 offset:49152
    ds_read_b64_tr_b16 a[162:163], v38 offset:49664
    v_mfma_f32_32x32x16_bf16 v[208:223], a[172:175], a[84:87], v[208:223]
    ds_read_b64_tr_b16 a[164:165], v42 offset:49152
    ds_read_b64_tr_b16 a[166:167], v42 offset:49664
    buffer_load_dwordx4 v11, s[16:19], s58 offen offset:1024 lds
    s_waitcnt lgkmcnt(8)
    v_mfma_f32_32x32x16_bf16 v[192:207], a[176:179], a[88:91], v[192:207]
    ds_read_b64_tr_b16 a[168:169], v39 offset:49152
    ds_read_b64_tr_b16 a[170:171], v39 offset:49664
    v_mfma_f32_32x32x16_bf16 v[208:223], a[180:183], a[88:91], v[208:223]
    ds_read_b64_tr_b16 a[172:173], v43 offset:49152
    ds_read_b64_tr_b16 a[174:175], v43 offset:49664
    buffer_load_dwordx4 v12, s[16:19], s58 offen offset:2048 lds
    s_waitcnt lgkmcnt(8)
    v_mfma_f32_32x32x16_bf16 v[192:207], a[184:187], a[92:95], v[192:207]
    ds_read_b64_tr_b16 a[176:177], v40 offset:49152
    ds_read_b64_tr_b16 a[178:179], v40 offset:49664
    v_mfma_f32_32x32x16_bf16 v[208:223], a[188:191], a[92:95], v[208:223]
    ds_read_b64_tr_b16 a[180:181], v44 offset:49152
    ds_read_b64_tr_b16 a[182:183], v44 offset:49664
    buffer_load_dwordx4 v13, s[16:19], s58 offen offset:3072 lds
    s_waitcnt lgkmcnt(8)
    v_mfma_f32_32x32x16_bf16 v[192:207], a[160:163], a[96:99], v[192:207]
    ds_read_b64_tr_b16 a[184:185], v41 offset:49152
    ds_read_b64_tr_b16 a[186:187], v41 offset:49664
    v_mfma_f32_32x32x16_bf16 v[208:223], a[164:167], a[96:99], v[208:223]
    ds_read_b64_tr_b16 a[188:189], v45 offset:49152
    ds_read_b64_tr_b16 a[190:191], v45 offset:49664
    s_waitcnt lgkmcnt(8)
    v_mfma_f32_32x32x16_bf16 v[192:207], a[168:171], a[100:103], v[192:207]
    ds_read_b64_tr_b16 a[160:161], v38 offset:57344
    ds_read_b64_tr_b16 a[162:163], v38 offset:57856
    v_mfma_f32_32x32x16_bf16 v[208:223], a[172:175], a[100:103], v[208:223]
    ds_read_b64_tr_b16 a[164:165], v42 offset:57344
    ds_read_b64_tr_b16 a[166:167], v42 offset:57856
    s_waitcnt lgkmcnt(8)
    v_mfma_f32_32x32x16_bf16 v[192:207], a[176:179], a[104:107], v[192:207]
    ds_read_b64_tr_b16 a[168:169], v39 offset:57344
    ds_read_b64_tr_b16 a[170:171], v39 offset:57856
    v_mfma_f32_32x32x16_bf16 v[208:223], a[180:183], a[104:107], v[208:223]
    ds_read_b64_tr_b16 a[172:173], v43 offset:57344
    ds_read_b64_tr_b16 a[174:175], v43 offset:57856
    s_waitcnt lgkmcnt(8)
    v_mfma_f32_32x32x16_bf16 v[192:207], a[184:187], a[108:111], v[192:207]
    ds_read_b64_tr_b16 a[176:177], v40 offset:57344
    ds_read_b64_tr_b16 a[178:179], v40 offset:57856
    v_mfma_f32_32x32x16_bf16 v[208:223], a[188:191], a[108:111], v[208:223]
    ds_read_b64_tr_b16 a[180:181], v44 offset:57344
    ds_read_b64_tr_b16 a[182:183], v44 offset:57856
    s_waitcnt lgkmcnt(8)
    v_mfma_f32_32x32x16_bf16 v[192:207], a[160:163], a[112:115], v[192:207]
    ds_read_b64_tr_b16 a[184:185], v41 offset:57344
    ds_read_b64_tr_b16 a[186:187], v41 offset:57856
    v_mfma_f32_32x32x16_bf16 v[208:223], a[164:167], a[112:115], v[208:223]
    ds_read_b64_tr_b16 a[188:189], v45 offset:57344
    ds_read_b64_tr_b16 a[190:191], v45 offset:57856
    s_waitcnt lgkmcnt(8)
    v_mfma_f32_32x32x16_bf16 v[192:207], a[168:171], a[116:119], v[192:207]
    s_waitcnt vmcnt(13)
    s_waitcnt lgkmcnt(0)
    s_barrier
    ds_read_b64_tr_b16 a[128:129], v30 offset:0
    ds_read_b64_tr_b16 a[130:131], v30 offset:512
    v_mfma_f32_32x32x16_bf16 v[208:223], a[172:175], a[116:119], v[208:223]
    ds_read_b64_tr_b16 a[132:133], v34 offset:0
    ds_read_b64_tr_b16 a[134:135], v34 offset:512
    v_mfma_f32_32x32x16_bf16 v[192:207], a[176:179], a[120:123], v[192:207]
    ds_read_b64_tr_b16 a[136:137], v31 offset:0
    ds_read_b64_tr_b16 a[138:139], v31 offset:512
    v_mfma_f32_32x32x16_bf16 v[208:223], a[180:183], a[120:123], v[208:223]
    ds_read_b64_tr_b16 a[140:141], v35 offset:0
    ds_read_b64_tr_b16 a[142:143], v35 offset:512
    v_mfma_f32_32x32x16_bf16 v[192:207], a[184:187], a[124:127], v[192:207]
    ds_read_b64_tr_b16 a[144:145], v32 offset:0
    ds_read_b64_tr_b16 a[146:147], v32 offset:512
    v_mfma_f32_32x32x16_bf16 v[208:223], a[188:191], a[124:127], v[208:223]
    ds_read_b64_tr_b16 a[148:149], v36 offset:0
    ds_read_b64_tr_b16 a[150:151], v36 offset:512
    s_waitcnt lgkmcnt(8)
    v_mfma_f32_32x32x16_bf16 v[224:239], a[128:131], a[0:3], 0
    ds_read_b64_tr_b16 a[152:153], v33 offset:0
    ds_read_b64_tr_b16 a[154:155], v33 offset:512
    s_nop 5
    v_mul_f32 v208, 0x3eb8aa3b, v208
    v_mul_f32 v209, 0x3eb8aa3b, v209
    v_cvt_pk_bf16_f32 v208, v208, v209
    v_mfma_f32_32x32x16_bf16 v[240:255], a[132:135], a[0:3], 0
    ds_read_b64_tr_b16 a[156:157], v37 offset:0
    ds_read_b64_tr_b16 a[158:159], v37 offset:512
    v_mul_f32 v210, 0x3eb8aa3b, v210
    v_mul_f32 v211, 0x3eb8aa3b, v211
    v_mfma_f32_16x16x32_bf16 v[58:61], v[50:53], a[128:131], 0
    v_mfma_f32_16x16x32_bf16 v[62:65], v[50:53], a[132:135], 0
    s_waitcnt lgkmcnt(8)
    v_mfma_f32_32x32x16_bf16 v[224:239], a[136:139], a[4:7], v[224:239]
    ds_read_b64_tr_b16 a[128:129], v30 offset:8192
    ds_read_b64_tr_b16 a[130:131], v30 offset:8704
    v_cvt_pk_bf16_f32 v209, v210, v211
    v_mul_f32 v212, 0x3eb8aa3b, v212
    v_mul_f32 v213, 0x3eb8aa3b, v213
    v_mfma_f32_32x32x16_bf16 v[240:255], a[140:143], a[4:7], v[240:255]
    ds_read_b64_tr_b16 a[132:133], v34 offset:8192
    ds_read_b64_tr_b16 a[134:135], v34 offset:8704
    v_cvt_pk_bf16_f32 v210, v212, v213
    v_mul_f32 v214, 0x3eb8aa3b, v214
    s_waitcnt lgkmcnt(8)
    v_mfma_f32_32x32x16_bf16 v[224:239], a[144:147], a[8:11], v[224:239]
    ds_read_b64_tr_b16 a[136:137], v31 offset:8192
    ds_read_b64_tr_b16 a[138:139], v31 offset:8704
    s_waitcnt vmcnt(9)
    s_mov_b64 exec, 63
    buffer_store_dword v109, v106, s[20:23], s78 offen sc1
    s_mov_b64 exec, -1
    v_mfma_f32_32x32x16_bf16 v[240:255], a[148:151], a[8:11], v[240:255]
    ds_read_b64_tr_b16 a[140:141], v35 offset:8192
    ds_read_b64_tr_b16 a[142:143], v35 offset:8704
    v_mul_f32 v215, 0x3eb8aa3b, v215
    v_cvt_pk_bf16_f32 v211, v214, v215
    s_waitcnt lgkmcnt(8)
    v_mfma_f32_32x32x16_bf16 v[224:239], a[152:155], a[12:15], v[224:239]
    ds_read_b64_tr_b16 a[144:145], v32 offset:8192
    ds_read_b64_tr_b16 a[146:147], v32 offset:8704
    v_mul_f32 v216, 0x3eb8aa3b, v216
    v_mul_f32 v217, 0x3eb8aa3b, v217
    v_cvt_pk_bf16_f32 v212, v216, v217
    v_mfma_f32_32x32x16_bf16 v[240:255], a[156:159], a[12:15], v[240:255]
    ds_read_b64_tr_b16 a[148:149], v36 offset:8192
    ds_read_b64_tr_b16 a[150:151], v36 offset:8704
    v_mul_f32 v218, 0x3eb8aa3b, v218
    v_mul_f32 v219, 0x3eb8aa3b, v219
    s_waitcnt lgkmcnt(8)
    v_mfma_f32_32x32x16_bf16 v[224:239], a[128:131], a[16:19], v[224:239]
    ds_read_b64_tr_b16 a[152:153], v33 offset:8192
    ds_read_b64_tr_b16 a[154:155], v33 offset:8704
    v_cvt_pk_bf16_f32 v213, v218, v219
    v_mul_f32 v220, 0x3eb8aa3b, v220
    v_mul_f32 v221, 0x3eb8aa3b, v221
    v_mfma_f32_32x32x16_bf16 v[240:255], a[132:135], a[16:19], v[240:255]
    ds_read_b64_tr_b16 a[156:157], v37 offset:8192
    ds_read_b64_tr_b16 a[158:159], v37 offset:8704
    v_cvt_pk_bf16_f32 v214, v220, v221
    v_mul_f32 v222, 0x3eb8aa3b, v222
    v_mfma_f32_16x16x32_bf16 v[58:61], v[50:53], a[128:131], v[58:61]
    v_mfma_f32_16x16x32_bf16 v[62:65], v[50:53], a[132:135], v[62:65]
    s_waitcnt lgkmcnt(8)
    v_mfma_f32_32x32x16_bf16 v[224:239], a[136:139], a[20:23], v[224:239]
    ds_read_b64_tr_b16 a[128:129], v30 offset:16384
    ds_read_b64_tr_b16 a[130:131], v30 offset:16896
    v_mul_f32 v223, 0x3eb8aa3b, v223
    v_cvt_pk_bf16_f32 v215, v222, v223
    s_waitcnt vmcnt(7)
    v_cmp_ne_u32 vcc, v109, v77
    s_nop 0
    s_cbranch_vccnz L_RCX_S
L_RCX_R:
    v_rsq_f32 v136, v75
    v_mfma_f32_32x32x16_bf16 v[240:255], a[140:143], a[20:23], v[240:255]
    ds_read_b64_tr_b16 a[132:133], v34 offset:16384
    ds_read_b64_tr_b16 a[134:135], v34 offset:16896
    buffer_store_dwordx4 v[208:211], v1, s[20:23], s77 offen offset:0 sc1
    v_add_f32 v142, 1.0, v76
    s_waitcnt lgkmcnt(8)
    v_mfma_f32_32x32x16_bf16 v[224:239], a[144:147], a[24:27], v[224:239]
    ds_read_b64_tr_b16 a[136:137], v31 offset:16384
    ds_read_b64_tr_b16 a[138:139], v31 offset:16896
    v_and_b32 v137, 0xffff0000, v74
    v_sub_f32 v137, v74, v137
    v_rcp_f32 v90, v142
    v_mfma_f32_32x32x16_bf16 v[240:255], a[148:151], a[24:27], v[240:255]
    ds_read_b64_tr_b16 a[140:141], v35 offset:16384
    ds_read_b64_tr_b16 a[142:143], v35 offset:16896
    buffer_store_dwordx4 v[212:215], v1, s[20:23], s77 offen offset:1024 sc1
    v_mul_f32 v141, v75, v136
    s_waitcnt lgkmcnt(8)
    v_mfma_f32_32x32x16_bf16 v[224:239], a[152:155], a[28:31], v[224:239]
    ds_read_b64_tr_b16 a[144:145], v32 offset:16384
    ds_read_b64_tr_b16 a[146:147], v32 offset:16896
    v_mul_f32 v86, v141, v142
    v_mul_f32 v82, 0xc0135761, v136
    v_mul_f32 v90, v90, v76
    v_mfma_f32_32x32x16_bf16 v[240:255], a[156:159], a[28:31], v[240:255]
    ds_read_b64_tr_b16 a[148:149], v36 offset:16384
    ds_read_b64_tr_b16 a[150:151], v36 offset:16896
    s_add_u32 m0, s62, 131072
    s_nop 0
    buffer_load_dwordx4 v14, s[16:19], s65 offen lds
    s_waitcnt lgkmcnt(8)
    v_mfma_f32_32x32x16_bf16 v[224:239], a[128:131], a[32:35], v[224:239]
    ds_read_b64_tr_b16 a[152:153], v33 offset:16384
    ds_read_b64_tr_b16 a[154:155], v33 offset:16896
    v_mul_f32 v84, v136, v136
    v_mul_f32 v84, v84, v136
    v_mul_f32 v84, 0xbdd2d3e8, v84
    v_mfma_f32_32x32x16_bf16 v[240:255], a[132:135], a[32:35], v[240:255]
    ds_read_b64_tr_b16 a[156:157], v37 offset:16384
    ds_read_b64_tr_b16 a[158:159], v37 offset:16896
    v_and_b32 v138, 0xffff0000, v137
    v_sub_f32 v138, v137, v138
    v_mfma_f32_16x16x32_bf16 v[58:61], v[50:53], a[128:131], v[58:61]
    v_mfma_f32_16x16x32_bf16 v[62:65], v[50:53], a[132:135], v[62:65]
    s_waitcnt lgkmcnt(8)
    v_mfma_f32_32x32x16_bf16 v[224:239], a[136:139], a[36:39], v[224:239]
    ds_read_b64_tr_b16 a[128:129], v30 offset:24576
    ds_read_b64_tr_b16 a[130:131], v30 offset:25088
    s_add_u32 m0, s62, 131072
    s_nop 0
    buffer_load_dwordx4 v15, s[16:19], s65 offen offset:1024 lds
    v_mfma_f32_32x32x16_bf16 v[240:255], a[140:143], a[36:39], v[240:255]
    ds_read_b64_tr_b16 a[132:133], v34 offset:24576
    ds_read_b64_tr_b16 a[134:135], v34 offset:25088
    v_and_b32 v139, 0xffff0000, v141
    v_sub_f32 v139, v141, v139
    s_waitcnt lgkmcnt(8)
    v_mfma_f32_32x32x16_bf16 v[224:239], a[144:147], a[40:43], v[224:239]
    ds_read_b64_tr_b16 a[136:137], v31 offset:24576
    ds_read_b64_tr_b16 a[138:139], v31 offset:25088
    v_and_b32 v140, 0xffff0000, v139
    v_sub_f32 v140, v139, v140
    v_perm_b32 v78, v137, v74, s72
    v_mfma_f32_32x32x16_bf16 v[240:255], a[148:151], a[40:43], v[240:255]
    ds_read_b64_tr_b16 a[140:141], v35 offset:24576
    ds_read_b64_tr_b16 a[142:143], v35 offset:25088
    s_add_u32 m0, s62, 131072
    s_nop 0
    buffer_load_dwordx4 v16, s[16:19], s65 offen offset:2048 lds
    s_waitcnt lgkmcnt(8)
    v_mfma_f32_32x32x16_bf16 v[224:239], a[152:155], a[44:47], v[224:239]
    ds_read_b64_tr_b16 a[144:145], v32 offset:24576
    ds_read_b64_tr_b16 a[146:147], v32 offset:25088
    v_perm_b32 v79, v74, v138, s72
    v_perm_b32 v80, v74, v137, s72
    v_perm_b32 v81, v139, v141, s72
    v_mfma_f32_32x32x16_bf16 v[240:255], a[156:159], a[44:47], v[240:255]
    ds_read_b64_tr_b16 a[148:149], v36 offset:24576
    ds_read_b64_tr_b16 a[150:151], v36 offset:25088
    s_mov_b32 exec_lo, 0
    v_lshrrev_b32 v81, 16, v140
    v_mov_b32 v78, 0
    v_mov_b32 v79, 0
    v_mov_b32 v80, 0
    s_mov_b32 exec_lo, -1
    s_waitcnt lgkmcnt(8)
    v_mfma_f32_32x32x16_bf16 v[224:239], a[128:131], a[48:51], v[224:239]
    ds_read_b64_tr_b16 a[152:153], v33 offset:24576
    ds_read_b64_tr_b16 a[154:155], v33 offset:25088
    s_add_u32 m0, s62, 131072
    s_nop 0
    buffer_load_dwordx4 v17, s[16:19], s65 offen offset:3072 lds
    v_mfma_f32_32x32x16_bf16 v[240:255], a[132:135], a[48:51], v[240:255]
    ds_read_b64_tr_b16 a[156:157], v37 offset:24576
    ds_read_b64_tr_b16 a[158:159], v37 offset:25088
    v_mfma_f32_16x16x32_bf16 v[58:61], v[50:53], a[128:131], v[58:61]
    v_mfma_f32_16x16x32_bf16 v[62:65], v[50:53], a[132:135], v[62:65]
    s_waitcnt lgkmcnt(8)
    v_mfma_f32_32x32x16_bf16 v[224:239], a[136:139], a[52:55], v[224:239]
    s_waitcnt vmcnt(7)
    s_waitcnt lgkmcnt(0)
    s_barrier
    ds_read_b64_tr_b16 a[160:161], v30 offset:32768
    ds_read_b64_tr_b16 a[162:163], v30 offset:33280
    s_add_u32 m0, s62, 135168
    s_nop 0
    buffer_load_dwordx4 v14, s[16:19], s66 offen lds
    v_mfma_f32_32x32x16_bf16 v[240:255], a[140:143], a[52:55], v[240:255]
    ds_read_b64_tr_b16 a[164:165], v34 offset:32768
    ds_read_b64_tr_b16 a[166:167], v34 offset:33280
    ds_read_b64_tr_b16 a[168:169], v30 offset:40960
    ds_read_b64_tr_b16 a[170:171], v30 offset:41472
    v_mfma_f32_32x32x16_bf16 v[224:239], a[144:147], a[56:59], v[224:239]
    ds_read_b64_tr_b16 a[136:137], v31 offset:32768
    ds_read_b64_tr_b16 a[138:139], v31 offset:33280
    ds_read_b64_tr_b16 a[172:173], v34 offset:40960
    ds_read_b64_tr_b16 a[174:175], v34 offset:41472
    v_mfma_f32_32x32x16_bf16 v[240:255], a[148:151], a[56:59], v[240:255]
    ds_read_b64_tr_b16 a[140:141], v35 offset:32768
    ds_read_b64_tr_b16 a[142:143], v35 offset:33280
    s_add_u32 m0, s62, 135168
    s_nop 0
    buffer_load_dwordx4 v15, s[16:19], s66 offen offset:1024 lds
    s_load_dwordx8 s[8:15], s[24:25], 0 glc
    v_mfma_f32_32x32x16_bf16 v[224:239], a[152:155], a[60:63], v[224:239]
    ds_read_b64_tr_b16 a[144:145], v32 offset:32768
    ds_read_b64_tr_b16 a[146:147], v32 offset:33280
    ds_read_b64_tr_b16 a[176:177], v30 offset:49152
    ds_read_b64_tr_b16 a[178:179], v30 offset:49664
    v_mfma_f32_32x32x16_bf16 v[240:255], a[156:159], a[60:63], v[240:255]
    ds_read_b64_tr_b16 a[148:149], v36 offset:32768
    ds_read_b64_tr_b16 a[150:151], v36 offset:33280
    ds_read_b64_tr_b16 a[180:181], v34 offset:49152
    ds_read_b64_tr_b16 a[182:183], v34 offset:49664
    s_waitcnt lgkmcnt(15)
    v_mfma_f32_16x16x32_bf16 v[58:61], v[50:53], a[160:163], v[58:61]
    s_waitcnt lgkmcnt(15)
    v_mfma_f32_16x16x32_bf16 v[62:65], v[50:53], a[164:167], v[62:65]
    v_mfma_f32_32x32x16_bf16 v[224:239], a[160:163], a[64:67], v[224:239]
    ds_read_b64_tr_b16 a[152:153], v33 offset:32768
    ds_read_b64_tr_b16 a[154:155], v33 offset:33280
    s_add_u32 m0, s62, 135168
    s_nop 0
    buffer_load_dwordx4 v16, s[16:19], s66 offen offset:2048 lds
    v_mfma_f32_32x32x16_bf16 v[240:255], a[164:167], a[64:67], v[240:255]
    ds_read_b64_tr_b16 a[156:157], v37 offset:32768
    ds_read_b64_tr_b16 a[158:159], v37 offset:33280
    ds_read_b64_tr_b16 a[184:185], v30 offset:57344
    ds_read_b64_tr_b16 a[186:187], v30 offset:57856
    s_waitcnt lgkmcnt(15)
    v_mfma_f32_16x16x32_bf16 v[58:61], v[50:53], a[168:171], v[58:61]
    s_waitcnt lgkmcnt(15)
    v_mfma_f32_16x16x32_bf16 v[62:65], v[50:53], a[172:175], v[62:65]
    s_waitcnt lgkmcnt(14)
    v_mfma_f32_32x32x16_bf16 v[224:239], a[136:139], a[68:71], v[224:239]
    s_add_u32 m0, s62, 135168
    s_nop 0
    buffer_load_dwordx4 v17, s[16:19], s66 offen offset:3072 lds
    ds_read_b64_tr_b16 a[188:189], v34 offset:57344
    ds_read_b64_tr_b16 a[190:191], v34 offset:57856
    v_mfma_f32_32x32x16_bf16 v[240:255], a[140:143], a[68:71], v[240:255]
    s_waitcnt lgkmcnt(12)
    v_mfma_f32_16x16x32_bf16 v[58:61], v[50:53], a[176:179], v[58:61]
    s_waitcnt lgkmcnt(8)
    v_mfma_f32_16x16x32_bf16 v[62:65], v[50:53], a[180:183], v[62:65]
    v_mfma_f32_32x32x16_bf16 v[224:239], a[144:147], a[72:75], v[224:239]
    ds_read_b64_tr_b16 a[136:137], v31 offset:40960
    ds_read_b64_tr_b16 a[138:139], v31 offset:41472
    s_waitcnt vmcnt(8)
    s_mov_b64 exec, 1
    buffer_store_dword v109, v110, s[20:23], s55 offen offset:536 sc1
    buffer_store_dword v109, v110, s[20:23], s55 offen offset:540 sc1
    s_mov_b64 exec, -1
    v_mfma_f32_32x32x16_bf16 v[240:255], a[148:151], a[72:75], v[240:255]
    ds_read_b64_tr_b16 a[140:141], v35 offset:40960
    ds_read_b64_tr_b16 a[142:143], v35 offset:41472
    s_bfe_u32 s82, s61, 262144
    s_lshl_b32 s82, s82, 15
    s_add_u32 m0, s60, 65536
    s_add_u32 s82, s82, s3
    buffer_load_dwordx4 v18, s[32:35], s82 offen lds
    s_waitcnt lgkmcnt(6)
    v_mfma_f32_16x16x32_bf16 v[58:61], v[50:53], a[184:187], v[58:61]
    s_waitcnt lgkmcnt(4)
    v_mfma_f32_16x16x32_bf16 v[62:65], v[50:53], a[188:191], v[62:65]
    v_mfma_f32_32x32x16_bf16 v[224:239], a[152:155], a[76:79], v[224:239]
    ds_read_b64_tr_b16 a[144:145], v32 offset:40960
    ds_read_b64_tr_b16 a[146:147], v32 offset:41472
    buffer_load_dwordx4 v19, s[32:35], s82 offen offset:1024 lds
    v_mfma_f32_32x32x16_bf16 v[240:255], a[156:159], a[76:79], v[240:255]
    ds_read_b64_tr_b16 a[148:149], v36 offset:40960
    ds_read_b64_tr_b16 a[150:151], v36 offset:41472
    ds_write_b32 v88, v58 offset:0
    ds_write_b32 v88, v62 offset:512
    v_mfma_f32_32x32x16_bf16 v[224:239], a[168:171], a[80:83], v[224:239]
    s_waitcnt lgkmcnt(0)
    s_cmp_lt_u32 s53, 2
    s_cselect_b64 s[12:13], s[28:29], s[12:13]
    s_cmp_lt_u32 s53, 1
    s_cselect_b64 s[10:11], s[28:29], s[10:11]
    s_cmp_eq_u64 s[8:9], s[28:29]
    s_cbranch_scc0 L_P1X_S
    s_cmp_eq_u64 s[10:11], s[28:29]
    s_cbranch_scc0 L_P1X_S
    s_cmp_eq_u64 s[12:13], s[28:29]
    s_cbranch_scc0 L_P1X_S
L_P1X_R:
    ds_write_b32 v98, v99 offset:3072
    buffer_load_dwordx4 v20, s[32:35], s82 offen offset:2048 lds
    buffer_load_dwordx4 v21, s[32:35], s82 offen offset:3072 lds
    s_waitcnt lgkmcnt(0)
    s_barrier
    ds_read_b128 v[144:147], v89 offset:0
    ds_read_b128 v[148:151], v89 offset:512
    ds_read_b64_tr_b16 a[152:153], v33 offset:40960
    ds_read_b64_tr_b16 a[154:155], v33 offset:41472
    s_add_u32 m0, s83, 33024
    s_nop 0
    buffer_load_dwordx4 v1, s[20:23], s93 offen offset:0 sc1 lds
    v_mfma_f32_32x32x16_bf16 v[240:255], a[172:175], a[80:83], v[240:255]
    ds_read_b64_tr_b16 a[156:157], v37 offset:40960
    ds_read_b64_tr_b16 a[158:159], v37 offset:41472
    s_waitcnt lgkmcnt(5)
    v_add_f32 v144, v144, v145
    v_add_f32 v146, v146, v147
    v_mfma_f32_32x32x16_bf16 v[224:239], a[136:139], a[84:87], v[224:239]
    buffer_load_dwordx4 v1, s[20:23], s93 offen offset:1024 sc1 lds
    v_lshl_or_b32 v61, v54, 16, v54
    v_add_f32 v144, v144, v146
    v_and_b32 v145, 0xffff0000, v144
    v_perm_b32 v58, v144, v144, s72
    v_mfma_f32_32x32x16_bf16 v[240:255], a[140:143], a[84:87], v[240:255]
    v_sub_f32 v145, v144, v145
    v_and_b32 v146, 0xffff0000, v145
    v_perm_b32 v59, v145, v144, s72
    v_sub_f32 v146, v145, v146
    v_mfma_f32_32x32x16_bf16 v[224:239], a[144:147], a[88:91], v[224:239]
    ds_read_b64_tr_b16 a[136:137], v31 offset:49152
    ds_read_b64_tr_b16 a[138:139], v31 offset:49664
    buffer_load_dwordx4 v1, s[20:23], s93 offen offset:2048 sc1 lds
    v_perm_b32 v60, v146, v145, s72
    s_waitcnt lgkmcnt(6)
    v_add_f32 v148, v148, v149
    v_mfma_f32_32x32x16_bf16 v[240:255], a[148:151], a[88:91], v[240:255]
    ds_read_b64_tr_b16 a[140:141], v35 offset:49152
    ds_read_b64_tr_b16 a[142:143], v35 offset:49664
    v_add_f32 v150, v150, v151
    v_lshl_or_b32 v65, v55, 16, v55
    s_waitcnt lgkmcnt(4)
    v_mfma_f32_32x32x16_bf16 v[224:239], a[152:155], a[92:95], v[224:239]
    ds_read_b64_tr_b16 a[144:145], v32 offset:49152
    ds_read_b64_tr_b16 a[146:147], v32 offset:49664
    s_add_u32 m0, s83, 33040
    s_nop 0
    buffer_load_dwordx4 v1, s[20:23], s93 offen offset:3072 sc1 lds
    v_mfma_f32_32x32x16_bf16 v[240:255], a[156:159], a[92:95], v[240:255]
    ds_read_b64_tr_b16 a[148:149], v36 offset:49152
    ds_read_b64_tr_b16 a[150:151], v36 offset:49664
    v_add_f32 v148, v148, v150
    v_and_b32 v149, 0xffff0000, v148
    v_mfma_f32_32x32x16_bf16 v[224:239], a[176:179], a[96:99], v[224:239]
    ds_read_b64_tr_b16 a[152:153], v33 offset:49152
    ds_read_b64_tr_b16 a[154:155], v33 offset:49664
    s_add_u32 m0, s83, 16512
    s_nop 0
    buffer_load_dwordx4 v91, s[20:23], s92 offen offset:0 sc1 lds
    v_mfma_f32_32x32x16_bf16 v[240:255], a[180:183], a[96:99], v[240:255]
    ds_read_b64_tr_b16 a[156:157], v37 offset:49152
    ds_read_b64_tr_b16 a[158:159], v37 offset:49664
    v_perm_b32 v62, v148, v148, s72
    v_sub_f32 v149, v148, v149
    s_waitcnt lgkmcnt(8)
    v_mfma_f32_32x32x16_bf16 v[224:239], a[136:139], a[100:103], v[224:239]
    buffer_load_dwordx4 v91, s[20:23], s92 offen offset:1024 sc1 lds
    v_and_b32 v150, 0xffff0000, v149
    v_perm_b32 v63, v149, v148, s72
    v_sub_f32 v150, v149, v150
    v_perm_b32 v64, v150, v149, s72
    v_mfma_f32_32x32x16_bf16 v[240:255], a[140:143], a[100:103], v[240:255]
    v_mul_f32 v192, 0x3eb8aa3b, v192
    v_mul_f32 v193, 0x3eb8aa3b, v193
    v_cvt_pk_bf16_f32 v2, v192, v193
    v_mul_f32 v194, 0x3eb8aa3b, v194
    s_waitcnt lgkmcnt(4)
    v_mfma_f32_32x32x16_bf16 v[224:239], a[144:147], a[104:107], v[224:239]
    ds_read_b64_tr_b16 a[136:137], v31 offset:57344
    ds_read_b64_tr_b16 a[138:139], v31 offset:57856
    buffer_load_dwordx4 v91, s[20:23], s92 offen offset:2048 sc1 lds
    v_mul_f32 v195, 0x3eb8aa3b, v195
    v_cvt_pk_bf16_f32 v3, v194, v195
    v_mfma_f32_32x32x16_bf16 v[240:255], a[148:151], a[104:107], v[240:255]
    ds_read_b64_tr_b16 a[140:141], v35 offset:57344
    ds_read_b64_tr_b16 a[142:143], v35 offset:57856
    v_mul_f32 v196, 0x3eb8aa3b, v196
    v_mul_f32 v197, 0x3eb8aa3b, v197
    s_waitcnt lgkmcnt(4)
    v_mfma_f32_32x32x16_bf16 v[224:239], a[152:155], a[108:111], v[224:239]
    ds_read_b64_tr_b16 a[144:145], v32 offset:57344
    ds_read_b64_tr_b16 a[146:147], v32 offset:57856
    s_add_u32 m0, s83, 16528
    s_nop 0
    buffer_load_dwordx4 v91, s[20:23], s92 offen offset:3072 sc1 lds
    v_mfma_f32_32x32x16_bf16 v[240:255], a[156:159], a[108:111], v[240:255]
    ds_read_b64_tr_b16 a[148:149], v36 offset:57344
    ds_read_b64_tr_b16 a[150:151], v36 offset:57856
    v_cvt_pk_bf16_f32 v4, v196, v197
    v_mul_f32 v198, 0x3eb8aa3b, v198
    v_mfma_f32_32x32x16_bf16 v[224:239], a[184:187], a[112:115], v[224:239]
    ds_read_b64_tr_b16 a[152:153], v33 offset:57344
    ds_read_b64_tr_b16 a[154:155], v33 offset:57856
    s_add_u32 m0, s83, 0
    s_nop 0
    buffer_load_dwordx4 v92, s[20:23], s91 offen offset:0 sc1 lds
    v_mfma_f32_32x32x16_bf16 v[240:255], a[188:191], a[112:115], v[240:255]
    ds_read_b64_tr_b16 a[156:157], v37 offset:57344
    ds_read_b64_tr_b16 a[158:159], v37 offset:57856
    v_mul_f32 v199, 0x3eb8aa3b, v199
    v_cvt_pk_bf16_f32 v5, v198, v199
    s_waitcnt lgkmcnt(8)
    v_mfma_f32_32x32x16_bf16 v[224:239], a[136:139], a[116:119], v[224:239]
    buffer_load_dwordx4 v92, s[20:23], s91 offen offset:1024 sc1 lds
    v_mul_f32 v200, 0x3eb8aa3b, v200
    v_mul_f32 v201, 0x3eb8aa3b, v201
    v_cvt_pk_bf16_f32 v6, v200, v201
    v_mul_f32 v202, 0x3eb8aa3b, v202
    v_mfma_f32_32x32x16_bf16 v[240:255], a[140:143], a[116:119], v[240:255]
    v_mul_f32 v203, 0x3eb8aa3b, v203
    v_cvt_pk_bf16_f32 v7, v202, v203
    v_mul_f32 v204, 0x3eb8aa3b, v204
    v_mul_f32 v205, 0x3eb8aa3b, v205
    s_waitcnt lgkmcnt(4)
    v_mfma_f32_32x32x16_bf16 v[224:239], a[144:147], a[120:123], v[224:239]
    buffer_load_dwordx4 v92, s[20:23], s91 offen offset:2048 sc1 lds
    v_cvt_pk_bf16_f32 v8, v204, v205
    v_mul_f32 v206, 0x3eb8aa3b, v206
    v_mul_f32 v207, 0x3eb8aa3b, v207
    v_cvt_pk_bf16_f32 v9, v206, v207
    v_mfma_f32_32x32x16_bf16 v[240:255], a[148:151], a[120:123], v[240:255]
    s_waitcnt lgkmcnt(0)
    v_mfma_f32_32x32x16_bf16 v[224:239], a[152:155], a[124:127], v[224:239]
    s_add_u32 m0, s83, 16
    s_nop 0
    buffer_load_dwordx4 v92, s[20:23], s91 offen offset:3072 sc1 lds
    v_mfma_f32_32x32x16_bf16 v[240:255], a[156:159], a[124:127], v[240:255]
    v_mfma_f32_32x32x16_bf16 v[224:239], v[58:61], v[78:81], v[224:239]
    s_bfe_u32 s82, s61, 262148
    s_lshl_b32 s82, s82, 15
    s_add_u32 m0, s60, 81920
    s_add_u32 s82, s82, s3
    buffer_load_dwordx4 v18, s[32:35], s82 offen lds
    v_mfma_f32_32x32x16_bf16 v[240:255], v[62:65], v[78:81], v[240:255]
    s_waitcnt vmcnt(19)
    s_barrier
    s_nop 3
    v_pk_mul_f32 v[136:137], v[224:225], v[224:225]
    v_pk_mul_f32 v[138:139], v[226:227], v[226:227]
    v_pk_mul_f32 v[140:141], v[228:229], v[228:229]
    v_pk_mul_f32 v[142:143], v[230:231], v[230:231]
    v_pk_mul_f32 v[144:145], v[232:233], v[232:233]
    v_pk_mul_f32 v[146:147], v[234:235], v[234:235]
    v_pk_mul_f32 v[148:149], v[236:237], v[236:237]
    v_pk_mul_f32 v[150:151], v[238:239], v[238:239]
    v_pk_fma_f32 v[136:137], v[136:137], v[84:85], v[82:83] op_sel_hi:[1,0,0]
    v_pk_fma_f32 v[138:139], v[138:139], v[84:85], v[82:83] op_sel_hi:[1,0,0]
    v_pk_fma_f32 v[140:141], v[140:141], v[84:85], v[82:83] op_sel_hi:[1,0,0]
    v_pk_fma_f32 v[142:143], v[142:143], v[84:85], v[82:83] op_sel_hi:[1,0,0]
    v_pk_fma_f32 v[144:145], v[144:145], v[84:85], v[82:83] op_sel_hi:[1,0,0]
    v_pk_fma_f32 v[146:147], v[146:147], v[84:85], v[82:83] op_sel_hi:[1,0,0]
    v_pk_fma_f32 v[148:149], v[148:149], v[84:85], v[82:83] op_sel_hi:[1,0,0]
    v_pk_fma_f32 v[150:151], v[150:151], v[84:85], v[82:83] op_sel_hi:[1,0,0]
    buffer_load_dwordx4 v19, s[32:35], s82 offen offset:1024 lds
    v_pk_mul_f32 v[136:137], v[136:137], v[224:225]
    v_pk_mul_f32 v[138:139], v[138:139], v[226:227]
    v_pk_mul_f32 v[140:141], v[140:141], v[228:229]
    v_pk_mul_f32 v[142:143], v[142:143], v[230:231]
    v_pk_mul_f32 v[144:145], v[144:145], v[232:233]
    v_pk_mul_f32 v[146:147], v[146:147], v[234:235]
    v_pk_mul_f32 v[148:149], v[148:149], v[236:237]
    v_pk_mul_f32 v[150:151], v[150:151], v[238:239]
    v_exp_f32 v136, v136
    v_exp_f32 v137, v137
    v_exp_f32 v138, v138
    v_exp_f32 v139, v139
    buffer_load_dwordx4 v20, s[32:35], s82 offen offset:2048 lds
    v_exp_f32 v140, v140
    v_exp_f32 v141, v141
    v_exp_f32 v142, v142
    v_exp_f32 v143, v143
    v_exp_f32 v144, v144
    v_exp_f32 v145, v145
    v_exp_f32 v146, v146
    v_exp_f32 v147, v147
    buffer_load_dwordx4 v21, s[32:35], s82 offen offset:3072 lds
    v_exp_f32 v148, v148
    v_exp_f32 v149, v149
    v_exp_f32 v150, v150
    v_exp_f32 v151, v151
    v_pk_fma_f32 v[136:137], v[136:137], v[86:87], v[86:87] op_sel_hi:[1,0,0]
    v_pk_fma_f32 v[138:139], v[138:139], v[86:87], v[86:87] op_sel_hi:[1,0,0]
    v_pk_fma_f32 v[140:141], v[140:141], v[86:87], v[86:87] op_sel_hi:[1,0,0]
    v_pk_fma_f32 v[142:143], v[142:143], v[86:87], v[86:87] op_sel_hi:[1,0,0]
    v_pk_fma_f32 v[144:145], v[144:145], v[86:87], v[86:87] op_sel_hi:[1,0,0]
    v_pk_fma_f32 v[146:147], v[146:147], v[86:87], v[86:87] op_sel_hi:[1,0,0]
    v_pk_fma_f32 v[148:149], v[148:149], v[86:87], v[86:87] op_sel_hi:[1,0,0]
    v_pk_fma_f32 v[150:151], v[150:151], v[86:87], v[86:87] op_sel_hi:[1,0,0]
    s_bfe_u32 s82, s61, 262152
    s_lshl_b32 s82, s82, 15
    s_add_u32 m0, s60, 98304
    s_add_u32 s82, s82, s3
    buffer_load_dwordx4 v18, s[32:35], s82 offen lds
    v_rcp_f32 v136, v136
    v_rcp_f32 v137, v137
    v_rcp_f32 v138, v138
    v_rcp_f32 v139, v139
    v_rcp_f32 v140, v140
    v_rcp_f32 v141, v141
    v_rcp_f32 v142, v142
    v_rcp_f32 v143, v143
    buffer_load_dwordx4 v19, s[32:35], s82 offen offset:1024 lds
    v_rcp_f32 v144, v144
    v_rcp_f32 v145, v145
    v_rcp_f32 v146, v146
    v_rcp_f32 v147, v147
    v_rcp_f32 v148, v148
    v_rcp_f32 v149, v149
    v_rcp_f32 v150, v150
    v_rcp_f32 v151, v151
    buffer_load_dwordx4 v20, s[32:35], s82 offen offset:2048 lds
    v_pk_mul_f32 v[136:137], v[136:137], v[224:225]
    v_pk_mul_f32 v[138:139], v[138:139], v[226:227]
    v_pk_mul_f32 v[140:141], v[140:141], v[228:229]
    v_pk_mul_f32 v[142:143], v[142:143], v[230:231]
    v_pk_mul_f32 v[144:145], v[144:145], v[232:233]
    v_pk_mul_f32 v[146:147], v[146:147], v[234:235]
    v_pk_mul_f32 v[148:149], v[148:149], v[236:237]
    v_pk_mul_f32 v[150:151], v[150:151], v[238:239]
    v_cvt_pk_bf16_f32 v224, v136, v137
    v_cvt_pk_bf16_f32 v225, v138, v139
    v_cvt_pk_bf16_f32 v226, v140, v141
    v_cvt_pk_bf16_f32 v227, v142, v143
    v_cvt_pk_bf16_f32 v228, v144, v145
    v_cvt_pk_bf16_f32 v229, v146, v147
    v_cvt_pk_bf16_f32 v230, v148, v149
    v_cvt_pk_bf16_f32 v231, v150, v151
    s_add_u32 s94, s68, 0
    s_lshl_b32 s94, s94, 11
    s_add_u32 s94, s94, s71
    buffer_store_dwordx4 v[224:227], v1, s[20:23], s94 offen sc1
    v_pk_mul_f32 v[136:137], v[240:241], v[240:241]
    v_pk_mul_f32 v[138:139], v[242:243], v[242:243]
    v_pk_mul_f32 v[140:141], v[244:245], v[244:245]
    v_pk_mul_f32 v[142:143], v[246:247], v[246:247]
    v_pk_mul_f32 v[144:145], v[248:249], v[248:249]
    v_pk_mul_f32 v[146:147], v[250:251], v[250:251]
    v_pk_mul_f32 v[148:149], v[252:253], v[252:253]
    v_pk_mul_f32 v[150:151], v[254:255], v[254:255]
    v_pk_fma_f32 v[136:137], v[136:137], v[84:85], v[82:83] op_sel_hi:[1,0,0]
    v_pk_fma_f32 v[138:139], v[138:139], v[84:85], v[82:83] op_sel_hi:[1,0,0]
    v_pk_fma_f32 v[140:141], v[140:141], v[84:85], v[82:83] op_sel_hi:[1,0,0]
    v_pk_fma_f32 v[142:143], v[142:143], v[84:85], v[82:83] op_sel_hi:[1,0,0]
    v_pk_fma_f32 v[144:145], v[144:145], v[84:85], v[82:83] op_sel_hi:[1,0,0]
    v_pk_fma_f32 v[146:147], v[146:147], v[84:85], v[82:83] op_sel_hi:[1,0,0]
    v_pk_fma_f32 v[148:149], v[148:149], v[84:85], v[82:83] op_sel_hi:[1,0,0]
    v_pk_fma_f32 v[150:151], v[150:151], v[84:85], v[82:83] op_sel_hi:[1,0,0]
    buffer_store_dwordx4 v[228:231], v1, s[20:23], s94 offen offset:1024 sc1
    ds_read_b64_tr_b16 v[176:177], v46 offset:0
    ds_read_b64_tr_b16 v[178:179], v46 offset:256
    v_pk_mul_f32 v[136:137], v[136:137], v[240:241]
    v_pk_mul_f32 v[138:139], v[138:139], v[242:243]
    v_pk_mul_f32 v[140:141], v[140:141], v[244:245]
    v_pk_mul_f32 v[142:143], v[142:143], v[246:247]
    v_pk_mul_f32 v[144:145], v[144:145], v[248:249]
    v_pk_mul_f32 v[146:147], v[146:147], v[250:251]
    v_pk_mul_f32 v[148:149], v[148:149], v[252:253]
    v_pk_mul_f32 v[150:151], v[150:151], v[254:255]
    v_exp_f32 v136, v136
    v_exp_f32 v137, v137
    v_exp_f32 v138, v138
    v_exp_f32 v139, v139
    buffer_load_dwordx4 v21, s[32:35], s82 offen offset:3072 lds
    ds_read_b64_tr_b16 a[132:133], v47 offset:0
    ds_read_b64_tr_b16 a[134:135], v47 offset:256
    v_exp_f32 v140, v140
    v_exp_f32 v141, v141
    v_exp_f32 v142, v142
    v_exp_f32 v143, v143
    v_exp_f32 v144, v144
    v_exp_f32 v145, v145
    v_exp_f32 v146, v146
    v_exp_f32 v147, v147
    s_bfe_u32 s82, s61, 262156
    s_lshl_b32 s82, s82, 15
    s_add_u32 m0, s60, 114688
    s_add_u32 s82, s82, s3
    buffer_load_dwordx4 v18, s[32:35], s82 offen lds
    ds_read_b64_tr_b16 a[136:137], v48 offset:0
    v_exp_f32 v148, v148
    v_exp_f32 v149, v149
    v_exp_f32 v150, v150
    v_exp_f32 v151, v151
    v_pk_fma_f32 v[136:137], v[136:137], v[86:87], v[86:87] op_sel_hi:[1,0,0]
    v_pk_fma_f32 v[138:139], v[138:139], v[86:87], v[86:87] op_sel_hi:[1,0,0]
    v_pk_fma_f32 v[140:141], v[140:141], v[86:87], v[86:87] op_sel_hi:[1,0,0]
    v_pk_fma_f32 v[142:143], v[142:143], v[86:87], v[86:87] op_sel_hi:[1,0,0]
    v_pk_fma_f32 v[144:145], v[144:145], v[86:87], v[86:87] op_sel_hi:[1,0,0]
    v_pk_fma_f32 v[146:147], v[146:147], v[86:87], v[86:87] op_sel_hi:[1,0,0]
    v_pk_fma_f32 v[148:149], v[148:149], v[86:87], v[86:87] op_sel_hi:[1,0,0]
    v_pk_fma_f32 v[150:151], v[150:151], v[86:87], v[86:87] op_sel_hi:[1,0,0]
    buffer_load_dwordx4 v19, s[32:35], s82 offen offset:1024 lds
    ds_read_b64_tr_b16 a[138:139], v48 offset:256
    ds_read_b64_tr_b16 a[140:141], v49 offset:0
    v_rcp_f32 v136, v136
    v_rcp_f32 v137, v137
    v_rcp_f32 v138, v138
    v_rcp_f32 v139, v139
    v_rcp_f32 v140, v140
    v_rcp_f32 v141, v141
    v_rcp_f32 v142, v142
    v_rcp_f32 v143, v143
    buffer_load_dwordx4 v20, s[32:35], s82 offen offset:2048 lds
    ds_read_b64_tr_b16 a[142:143], v49 offset:256
    ds_read_b64_tr_b16 v[180:181], v46 offset:4096
    v_rcp_f32 v144, v144
    v_rcp_f32 v145, v145
    v_rcp_f32 v146, v146
    v_rcp_f32 v147, v147
    v_rcp_f32 v148, v148
    v_rcp_f32 v149, v149
    v_rcp_f32 v150, v150
    v_rcp_f32 v151, v151
    buffer_load_dwordx4 v21, s[32:35], s82 offen offset:3072 lds
    ds_read_b64_tr_b16 v[182:183], v46 offset:4352
    ds_read_b64_tr_b16 a[148:149], v47 offset:4096
    v_pk_mul_f32 v[136:137], v[136:137], v[240:241]
    v_pk_mul_f32 v[138:139], v[138:139], v[242:243]
    v_pk_mul_f32 v[140:141], v[140:141], v[244:245]
    v_pk_mul_f32 v[142:143], v[142:143], v[246:247]
    v_pk_mul_f32 v[144:145], v[144:145], v[248:249]
    v_pk_mul_f32 v[146:147], v[146:147], v[250:251]
    v_pk_mul_f32 v[148:149], v[148:149], v[252:253]
    v_pk_mul_f32 v[150:151], v[150:151], v[254:255]
    v_cvt_pk_bf16_f32 v240, v136, v137
    v_cvt_pk_bf16_f32 v241, v138, v139
    v_cvt_pk_bf16_f32 v242, v140, v141
    v_cvt_pk_bf16_f32 v243, v142, v143
    v_cvt_pk_bf16_f32 v244, v144, v145
    v_cvt_pk_bf16_f32 v245, v146, v147
    v_cvt_pk_bf16_f32 v246, v148, v149
    v_cvt_pk_bf16_f32 v247, v150, v151
    s_add_u32 s95, s68, 1
    s_lshl_b32 s95, s95, 11
    s_add_u32 s95, s95, s71
    buffer_store_dwordx4 v[240:243], v1, s[20:23], s95 offen sc1
    ds_read_b64_tr_b16 a[150:151], v47 offset:4352
    s_waitcnt lgkmcnt(8)
    v_mfma_f32_32x32x16_bf16 v[160:175], v[176:179], a[0:3], 0
    ds_read_b64_tr_b16 a[152:153], v48 offset:4096
    ds_read_b64_tr_b16 a[154:155], v48 offset:4352
    ds_read_b64_tr_b16 v[184:185], v46 offset:8192
    ds_read_b64_tr_b16 v[186:187], v46 offset:8448
    v_mfma_f32_32x32x16_bf16 v[160:175], a[132:135], a[4:7], v[160:175]
    ds_read_b64_tr_b16 a[156:157], v49 offset:4096
    ds_read_b64_tr_b16 a[158:159], v49 offset:4352
    buffer_store_dwordx4 v[244:247], v1, s[20:23], s95 offen offset:1024 sc1
    ds_read_b64_tr_b16 v[188:189], v46 offset:12288
    s_waitcnt lgkmcnt(11)
    v_mfma_f32_32x32x16_bf16 v[160:175], a[136:139], a[8:11], v[160:175]
    ds_read_b64_tr_b16 v[190:191], v46 offset:12544
    ds_read_b64_tr_b16 v[192:193], v46 offset:16384
    v_mfma_f32_32x32x16_bf16 v[160:175], a[140:143], a[12:15], v[160:175]
    ds_read_b64_tr_b16 a[132:133], v47 offset:8192
    ds_read_b64_tr_b16 a[134:135], v47 offset:8448
    ds_read_b64_tr_b16 v[194:195], v46 offset:16640
    ds_read_b64_tr_b16 v[196:197], v46 offset:20480
    v_mfma_f32_16x16x32_bf16 v[66:69], v[50:53], v[176:179], 0
    s_waitcnt lgkmcnt(15)
    v_mfma_f32_16x16x32_bf16 v[66:69], v[50:53], v[180:183], v[66:69]
    s_waitcnt lgkmcnt(13)
    v_mfma_f32_32x32x16_bf16 v[160:175], v[180:183], a[16:19], v[160:175]
    ds_read_b64_tr_b16 a[136:137], v48 offset:8192
    ds_read_b64_tr_b16 a[138:139], v48 offset:8448
    ds_read_b64_tr_b16 v[198:199], v46 offset:20736
    ds_read_b64_tr_b16 v[200:201], v46 offset:24576
    v_mfma_f32_32x32x16_bf16 v[160:175], a[148:151], a[20:23], v[160:175]
    ds_read_b64_tr_b16 a[140:141], v49 offset:8192
    ds_read_b64_tr_b16 a[142:143], v49 offset:8448
    ds_read_b64_tr_b16 v[202:203], v46 offset:24832
    ds_read_b64_tr_b16 v[204:205], v46 offset:28672
    s_waitcnt lgkmcnt(15)
    v_mfma_f32_16x16x32_bf16 v[66:69], v[50:53], v[184:187], v[66:69]
    s_waitcnt lgkmcnt(15)
    v_mfma_f32_32x32x16_bf16 v[160:175], a[152:155], a[24:27], v[160:175]
    ds_read_b64_tr_b16 v[206:207], v46 offset:28928
    s_waitcnt vmcnt(28)
    ds_read_b64_tr_b16 a[160:161], v102 offset:0
    v_mfma_f32_32x32x16_bf16 v[160:175], a[156:159], a[28:31], v[160:175]
    ds_read_b64_tr_b16 a[148:149], v47 offset:12288
    ds_read_b64_tr_b16 a[150:151], v47 offset:12544
    ds_read_b64_tr_b16 a[162:163], v102 offset:1024
    ds_read_b64_tr_b16 a[164:165], v103 offset:0
    s_waitcnt lgkmcnt(15)
    v_mfma_f32_16x16x32_bf16 v[66:69], v[50:53], v[188:191], v[66:69]
    s_waitcnt lgkmcnt(15)
    v_mfma_f32_16x16x32_bf16 v[66:69], v[50:53], v[192:195], v[66:69]
    v_mfma_f32_32x32x16_bf16 v[160:175], v[184:187], a[32:35], v[160:175]
    ds_read_b64_tr_b16 a[152:153], v48 offset:12288
    ds_read_b64_tr_b16 a[154:155], v48 offset:12544
    ds_read_b64_tr_b16 a[166:167], v103 offset:1024
    ds_read_b64_tr_b16 a[168:169], v102 offset:2048
    v_mfma_f32_32x32x16_bf16 v[160:175], a[132:135], a[36:39], v[160:175]
    ds_read_b64_tr_b16 a[156:157], v49 offset:12288
    ds_read_b64_tr_b16 a[158:159], v49 offset:12544
    ds_read_b64_tr_b16 a[170:171], v102 offset:3072
    ds_read_b64_tr_b16 a[172:173], v103 offset:2048
    s_waitcnt lgkmcnt(15)
    v_mfma_f32_16x16x32_bf16 v[66:69], v[50:53], v[196:199], v[66:69]
    s_waitcnt lgkmcnt(15)
    v_mfma_f32_32x32x16_bf16 v[160:175], a[136:139], a[40:43], v[160:175]
    ds_read_b64_tr_b16 a[174:175], v103 offset:3072
    s_waitcnt vmcnt(12)
    ds_read_b64_tr_b16 a[176:177], v102 offset:16384
    v_mfma_f32_32x32x16_bf16 v[160:175], a[140:143], a[44:47], v[160:175]
    ds_read_b64_tr_b16 a[132:133], v47 offset:16384
    ds_read_b64_tr_b16 a[134:135], v47 offset:16640
    s_waitcnt lgkmcnt(3)
    s_bfe_u32 s82, s61, 262160
    s_lshl_b32 s82, s82, 15
    s_add_u32 m0, s60, 65536
    s_add_u32 s82, s82, s3
    buffer_load_dwordx4 v18, s[32:35], s82 offen lds
    v_mfma_f32_16x16x32_bf16 v[66:69], v[50:53], v[200:203], v[66:69]
    v_mfma_f32_16x16x32_bf16 v[66:69], v[50:53], v[204:207], v[66:69]
    v_mfma_f32_32x32x16_bf16 v[160:175], v[188:191], a[48:51], v[160:175]
    ds_read_b64_tr_b16 a[136:137], v48 offset:16384
    ds_read_b64_tr_b16 a[138:139], v48 offset:16640
    buffer_load_dwordx4 v19, s[32:35], s82 offen offset:1024 lds
    ds_read_b64_tr_b16 a[178:179], v102 offset:17408
    ds_read_b64_tr_b16 a[180:181], v103 offset:16384
    v_mfma_f32_32x32x16_bf16 v[160:175], a[148:151], a[52:55], v[160:175]
    ds_read_b64_tr_b16 a[140:141], v49 offset:16384
    ds_read_b64_tr_b16 a[142:143], v49 offset:16640
    ds_read_b64_tr_b16 a[182:183], v103 offset:17408
    ds_read_b64_tr_b16 a[184:185], v102 offset:18432
    v_mfma_f32_32x32x16_bf16 v[160:175], a[152:155], a[56:59], v[160:175]
    buffer_load_dwordx4 v20, s[32:35], s82 offen offset:2048 lds
    ds_read_b64_tr_b16 a[186:187], v102 offset:19456
    ds_read_b64_tr_b16 a[188:189], v103 offset:18432
    ds_write_b32 v88, v66 offset:1024
    v_mfma_f32_32x32x16_bf16 v[160:175], a[156:159], a[60:63], v[160:175]
    ds_read_b64_tr_b16 a[148:149], v47 offset:20480
    ds_read_b64_tr_b16 a[150:151], v47 offset:20736
    ds_read_b64_tr_b16 a[190:191], v103 offset:19456
    s_waitcnt vmcnt(9)
    ds_read_b64_tr_b16 a[192:193], v102 offset:32768
    s_waitcnt lgkmcnt(15)
    v_mfma_f32_32x32x16_bf16 v[160:175], v[192:195], a[64:67], v[160:175]
    s_waitcnt lgkmcnt(0)
    s_barrier
    ds_read_b128 v[152:155], v89 offset:1024
    ds_read_b64_tr_b16 a[152:153], v48 offset:20480
    ds_read_b64_tr_b16 a[154:155], v48 offset:20736
    buffer_load_dwordx4 v21, s[32:35], s82 offen offset:3072 lds
    ds_read_b64_tr_b16 a[194:195], v102 offset:33792
    ds_read_b64_tr_b16 a[196:197], v103 offset:32768
    v_mfma_f32_32x32x16_bf16 v[160:175], a[132:135], a[68:71], v[160:175]
    ds_read_b64_tr_b16 a[156:157], v49 offset:20480
    ds_read_b64_tr_b16 a[158:159], v49 offset:20736
    ds_read_b64_tr_b16 a[198:199], v103 offset:33792
    ds_read_b64_tr_b16 a[200:201], v102 offset:34816
    v_mfma_f32_32x32x16_bf16 v[160:175], a[136:139], a[72:75], v[160:175]
    s_bfe_u32 s82, s61, 262164
    s_lshl_b32 s82, s82, 15
    s_add_u32 m0, s60, 81920
    s_add_u32 s82, s82, s3
    buffer_load_dwordx4 v18, s[32:35], s82 offen lds
    v_mfma_f32_32x32x16_bf16 v[160:175], a[140:143], a[76:79], v[160:175]
    ds_read_b64_tr_b16 a[132:133], v47 offset:24576
    ds_read_b64_tr_b16 a[134:135], v47 offset:24832
    ds_read_b64_tr_b16 a[202:203], v102 offset:35840
    ds_read_b64_tr_b16 a[204:205], v103 offset:34816
    v_mfma_f32_32x32x16_bf16 v[160:175], v[196:199], a[80:83], v[160:175]
    ds_read_b64_tr_b16 a[136:137], v48 offset:24576
    ds_read_b64_tr_b16 a[138:139], v48 offset:24832
    buffer_load_dwordx4 v19, s[32:35], s82 offen offset:1024 lds
    ds_read_b64_tr_b16 a[206:207], v103 offset:35840
    s_waitcnt lgkmcnt(15)
    v_add_f32 v152, v152, v153
    v_mfma_f32_32x32x16_bf16 v[160:175], a[148:151], a[84:87], v[160:175]
    ds_read_b64_tr_b16 a[140:141], v49 offset:24576
    ds_read_b64_tr_b16 a[142:143], v49 offset:24832
    v_add_f32 v154, v154, v155
    v_lshl_or_b32 v69, v56, 16, v56
    s_waitcnt lgkmcnt(11)
    v_mfma_f32_32x32x16_bf16 v[160:175], a[152:155], a[88:91], v[160:175]
    buffer_load_dwordx4 v20, s[32:35], s82 offen offset:2048 lds
    v_add_f32 v152, v152, v154
    v_and_b32 v153, 0xffff0000, v152
    v_perm_b32 v66, v152, v152, s72
    v_sub_f32 v153, v152, v153
    v_mfma_f32_32x32x16_bf16 v[160:175], a[156:159], a[92:95], v[160:175]
    ds_read_b64_tr_b16 a[148:149], v47 offset:28672
    ds_read_b64_tr_b16 a[150:151], v47 offset:28928
    v_and_b32 v154, 0xffff0000, v153
    v_perm_b32 v67, v153, v152, s72
    s_waitcnt lgkmcnt(9)
    v_mfma_f32_32x32x16_bf16 v[160:175], v[200:203], a[96:99], v[160:175]
    ds_read_b64_tr_b16 a[152:153], v48 offset:28672
    ds_read_b64_tr_b16 a[154:155], v48 offset:28928
    buffer_load_dwordx4 v21, s[32:35], s82 offen offset:3072 lds
    v_sub_f32 v154, v153, v154
    v_perm_b32 v68, v154, v153, s72
    v_mfma_f32_32x32x16_bf16 v[160:175], a[132:135], a[100:103], v[160:175]
    ds_read_b64_tr_b16 a[156:157], v49 offset:28672
    ds_read_b64_tr_b16 a[158:159], v49 offset:28928
    s_waitcnt lgkmcnt(6)
    v_mfma_f32_32x32x16_bf16 v[160:175], a[136:139], a[104:107], v[160:175]
    v_mfma_f32_32x32x16_bf16 v[160:175], a[140:143], a[108:111], v[160:175]
    s_waitcnt lgkmcnt(4)
    v_mfma_f32_32x32x16_bf16 v[160:175], v[204:207], a[112:115], v[160:175]
    s_waitcnt vmcnt(8)
    s_mov_b64 exec, 0xff
    buffer_store_dword v109, v87, s[20:23], s78 offen offset:0 sc1
    s_mov_b64 exec, -1
    v_mfma_f32_32x32x16_bf16 v[160:175], a[148:151], a[116:119], v[160:175]
    s_waitcnt lgkmcnt(0)
    v_mfma_f32_32x32x16_bf16 v[160:175], a[152:155], a[120:123], v[160:175]
    v_mfma_f32_32x32x16_bf16 v[160:175], a[156:159], a[124:127], v[160:175]
    v_mfma_f32_32x32x16_bf16 v[160:175], v[66:69], v[78:81], v[160:175]
    s_nop 11
    v_pk_mul_f32 v[136:137], v[160:161], v[160:161]
    v_pk_mul_f32 v[138:139], v[162:163], v[162:163]
    v_pk_mul_f32 v[140:141], v[164:165], v[164:165]
    v_pk_mul_f32 v[142:143], v[166:167], v[166:167]
    v_pk_mul_f32 v[144:145], v[168:169], v[168:169]
    v_pk_mul_f32 v[146:147], v[170:171], v[170:171]
    v_pk_mul_f32 v[148:149], v[172:173], v[172:173]
    v_pk_mul_f32 v[150:151], v[174:175], v[174:175]
    v_pk_fma_f32 v[136:137], v[136:137], v[84:85], v[82:83] op_sel_hi:[1,0,0]
    v_pk_fma_f32 v[138:139], v[138:139], v[84:85], v[82:83] op_sel_hi:[1,0,0]
    v_pk_fma_f32 v[140:141], v[140:141], v[84:85], v[82:83] op_sel_hi:[1,0,0]
    v_pk_fma_f32 v[142:143], v[142:143], v[84:85], v[82:83] op_sel_hi:[1,0,0]
    v_pk_fma_f32 v[144:145], v[144:145], v[84:85], v[82:83] op_sel_hi:[1,0,0]
    v_pk_fma_f32 v[146:147], v[146:147], v[84:85], v[82:83] op_sel_hi:[1,0,0]
    v_pk_fma_f32 v[148:149], v[148:149], v[84:85], v[82:83] op_sel_hi:[1,0,0]
    v_pk_fma_f32 v[150:151], v[150:151], v[84:85], v[82:83] op_sel_hi:[1,0,0]
    v_pk_mul_f32 v[136:137], v[136:137], v[160:161]
    v_pk_mul_f32 v[138:139], v[138:139], v[162:163]
    v_pk_mul_f32 v[140:141], v[140:141], v[164:165]
    v_pk_mul_f32 v[142:143], v[142:143], v[166:167]
    v_pk_mul_f32 v[144:145], v[144:145], v[168:169]
    v_pk_mul_f32 v[146:147], v[146:147], v[170:171]
    v_pk_mul_f32 v[148:149], v[148:149], v[172:173]
    v_pk_mul_f32 v[150:151], v[150:151], v[174:175]
    v_exp_f32 v136, v136
    v_exp_f32 v137, v137
    v_exp_f32 v138, v138
    v_exp_f32 v139, v139
    v_exp_f32 v140, v140
    v_exp_f32 v141, v141
    v_exp_f32 v142, v142
    v_exp_f32 v143, v143
    v_exp_f32 v144, v144
    v_exp_f32 v145, v145
    v_exp_f32 v146, v146
    v_exp_f32 v147, v147
    v_exp_f32 v148, v148
    v_exp_f32 v149, v149
    v_exp_f32 v150, v150
    v_exp_f32 v151, v151
    v_pk_fma_f32 v[136:137], v[136:137], v[86:87], v[86:87] op_sel_hi:[1,0,0]
    v_pk_fma_f32 v[138:139], v[138:139], v[86:87], v[86:87] op_sel_hi:[1,0,0]
    v_pk_fma_f32 v[140:141], v[140:141], v[86:87], v[86:87] op_sel_hi:[1,0,0]
    v_pk_fma_f32 v[142:143], v[142:143], v[86:87], v[86:87] op_sel_hi:[1,0,0]
    v_pk_fma_f32 v[144:145], v[144:145], v[86:87], v[86:87] op_sel_hi:[1,0,0]
    v_pk_fma_f32 v[146:147], v[146:147], v[86:87], v[86:87] op_sel_hi:[1,0,0]
    v_pk_fma_f32 v[148:149], v[148:149], v[86:87], v[86:87] op_sel_hi:[1,0,0]
    v_pk_fma_f32 v[150:151], v[150:151], v[86:87], v[86:87] op_sel_hi:[1,0,0]
    v_rcp_f32 v136, v136
    v_rcp_f32 v137, v137
    v_rcp_f32 v138, v138
    v_rcp_f32 v139, v139
    v_rcp_f32 v140, v140
    v_rcp_f32 v141, v141
    v_rcp_f32 v142, v142
    v_rcp_f32 v143, v143
    v_rcp_f32 v144, v144
    v_rcp_f32 v145, v145
    v_rcp_f32 v146, v146
    v_rcp_f32 v147, v147
    v_rcp_f32 v148, v148
    v_rcp_f32 v149, v149
    v_rcp_f32 v150, v150
    v_rcp_f32 v151, v151
    v_pk_mul_f32 v[136:137], v[136:137], v[160:161]
    v_pk_mul_f32 v[138:139], v[138:139], v[162:163]
    v_pk_mul_f32 v[140:141], v[140:141], v[164:165]
    v_pk_mul_f32 v[142:143], v[142:143], v[166:167]
    v_pk_mul_f32 v[144:145], v[144:145], v[168:169]
    v_pk_mul_f32 v[146:147], v[146:147], v[170:171]
    v_pk_mul_f32 v[148:149], v[148:149], v[172:173]
    v_pk_mul_f32 v[150:151], v[150:151], v[174:175]
    v_cvt_pk_bf16_f32 v160, v136, v137
    v_cvt_pk_bf16_f32 v161, v138, v139
    v_cvt_pk_bf16_f32 v162, v140, v141
    v_cvt_pk_bf16_f32 v163, v142, v143
    v_cvt_pk_bf16_f32 v164, v144, v145
    v_cvt_pk_bf16_f32 v165, v146, v147
    v_cvt_pk_bf16_f32 v166, v148, v149
    v_cvt_pk_bf16_f32 v167, v150, v151
    s_add_u32 s96, s69, 0
    s_lshl_b32 s96, s96, 11
    s_add_u32 s96, s96, s71
    buffer_store_dwordx4 v[160:163], v1, s[20:23], s96 offen sc1
    buffer_store_dwordx4 v[164:167], v1, s[20:23], s96 offen offset:1024 sc1
    s_nop 1
    s_branch L_ATT
L_Y:
    s_lshl_b32 s73, s56, 9
    s_add_u32 s73, s73, 16777216
    v_lshrrev_b32 v137, 3, v0
    v_bfe_u32 v136, v0, 4, 1
    v_lshlrev_b32 v136, 2, v136
    v_and_b32 v10, 7, v0
    v_xor_b32 v136, v136, v10
    v_lshlrev_b32 v136, 4, v136
    v_mul_u32_u24 v10, 3584, v137
    v_add_u32 v10, v10, v136
    v_add_u32 v11, 27648, v10
    v_add_u32 v12, 27648, v11
    v_add_u32 v13, 27648, v12
    v_lshl_add_u32 v18, v137, 10, v136
    v_add_u32 v19, 7168, v18
    v_add_u32 v20, 7168, v19
    v_add_u32 v21, 7168, v20
    s_lshl_b32 s62, s52, 13
    s_xor_b32 s59, s52, s74
    s_lshl_b32 s63, s68, 6
    s_lshl_b32 s64, s67, 6
    s_and_b32 s96, s80, 4
    s_add_u32 s96, s96, s52
    s_mul_i32 s3, s96, 229376
    s_lshl_b32 s96, s81, 7
    s_add_u32 s3, s3, s96
    s_lshl_b32 s87, s52, 17
    s_add_u32 s87, s87, s96
    v_lshrrev_b32 v136, 5, v0
    v_mul_u32_u24 v100, 512, v136
    v_bfe_u32 v136, v0, 2, 2
    v_lshl_add_u32 v100, v136, 7, v100
    v_bfe_u32 v136, v0, 4, 1
    v_lshl_add_u32 v100, v136, 5, v100
    v_and_b32 v136, 3, v0
    v_lshl_add_u32 v100, v136, 3, v100
    v_bfe_u32 v136, v0, 3, 1
    v_lshl_add_u32 v100, v136, 6, v100
    s_and_b32 s96, s52, 1
    s_waitcnt vmcnt(6)
    v_add_u32 v109, 0x9e3779b9, v109
    v_max_u32 v109, 1, v109
    s_mov_b64 exec, 1
    buffer_store_dword v109, v108, s[48:51], 0 offen sc1
    buffer_store_dword v109, v108, s[20:23], s79 offen sc1
    s_mov_b64 exec, -1
    v_and_b32 v108, 0x1f0, v1
    buffer_load_dwordx4 v[232:235], v1, s[28:31], 0 offen
    buffer_load_dword a255, v148, s[16:19], s94 offen
    buffer_load_dword a254, v151, s[12:15], s99 offen
    buffer_load_ushort v54, v149, s[24:27], s95 offen
    buffer_load_ushort v55, v149, s[24:27], s95 offen offset:64
    buffer_load_ushort v56, v149, s[24:27], s101 offen
    buffer_load_ushort v57, v149, s[24:27], s101 offen offset:64
    buffer_load_dword a253, v110, s[20:23], s55 offen
    buffer_load_dword a252, v110, s[20:23], s90 offen
    buffer_load_dword a251, v110, s[40:43], s100 offen
    s_waitcnt lgkmcnt(0)
    s_barrier
    ds_read_b128 a[0:3], v22 offset:0
    ds_read_b64_tr_b16 a[128:129], v30 offset:0
    ds_read_b64_tr_b16 a[130:131], v30 offset:512
    ds_read_b64_tr_b16 a[132:133], v34 offset:0
    ds_read_b64_tr_b16 a[134:135], v34 offset:512
    ds_read_b128 a[4:7], v23 offset:0
    ds_read_b64_tr_b16 a[136:137], v31 offset:0
    ds_read_b64_tr_b16 a[138:139], v31 offset:512
    ds_read_b64_tr_b16 a[140:141], v35 offset:0
    ds_read_b64_tr_b16 a[142:143], v35 offset:512
    s_waitcnt lgkmcnt(5)
    v_mfma_f32_32x32x16_bf16 v[160:175], a[0:3], a[128:131], 0
    ds_read_b128 a[8:11], v24 offset:0
    ds_read_b64_tr_b16 a[144:145], v32 offset:0
    ds_read_b64_tr_b16 a[146:147], v32 offset:512
    s_lshl_b32 s96, s96, 6
    v_mfma_f32_32x32x16_bf16 v[176:191], a[0:3], a[132:135], 0
    ds_read_b64_tr_b16 a[148:149], v36 offset:0
    ds_read_b64_tr_b16 a[150:151], v36 offset:512
    s_add_u32 m0, s60, 98304
    s_xor_b32 s57, s75, 256
    buffer_load_dwordx4 v2, s[8:11], s57 offen lds
    s_waitcnt lgkmcnt(5)
    v_mfma_f32_32x32x16_bf16 v[160:175], a[4:7], a[136:139], v[160:175]
    ds_read_b128 a[12:15], v25 offset:0
    ds_read_b64_tr_b16 a[152:153], v33 offset:0
    ds_read_b64_tr_b16 a[154:155], v33 offset:512
    buffer_load_dwordx4 v3, s[8:11], s57 offen offset:1024 lds
    v_mfma_f32_32x32x16_bf16 v[176:191], a[4:7], a[140:143], v[176:191]
    ds_read_b64_tr_b16 a[156:157], v37 offset:0
    ds_read_b64_tr_b16 a[158:159], v37 offset:512
    buffer_load_dwordx4 v4, s[8:11], s57 offen offset:2048 lds
    s_waitcnt lgkmcnt(5)
    v_mfma_f32_32x32x16_bf16 v[160:175], a[8:11], a[144:147], v[160:175]
    buffer_load_dwordx4 v5, s[8:11], s57 offen offset:3072 lds
    s_xor_b32 s58, s74, 2
    s_add_u32 m0, s61, 16384
    s_mul_i32 s58, s58, 196608
    buffer_load_dwordx4 v26, s[12:15], s58 offen lds
    buffer_load_dwordx4 v27, s[12:15], s58 offen offset:1024 lds
    buffer_load_dwordx4 v[224:227], v1, s[8:11], s89 offen
    s_waitcnt vmcnt(19)
    s_waitcnt lgkmcnt(0)
    s_barrier
    ds_read_b128 a[16:19], v22 offset:16384
    ds_read_b64_tr_b16 a[128:129], v30 offset:8192
    ds_read_b64_tr_b16 a[130:131], v30 offset:8704
    buffer_load_dwordx4 v[228:231], v1, s[8:11], s89 offen offset:1024
    v_mfma_f32_32x32x16_bf16 v[176:191], a[8:11], a[148:151], v[176:191]
    ds_read_b64_tr_b16 a[132:133], v34 offset:8192
    ds_read_b64_tr_b16 a[134:135], v34 offset:8704
    s_add_u32 m0, s60, 114688
    s_xor_b32 s57, s75, 384
    buffer_load_dwordx4 v2, s[8:11], s57 offen lds
    v_mfma_f32_32x32x16_bf16 v[160:175], a[12:15], a[152:155], v[160:175]
    ds_read_b128 a[20:23], v23 offset:16384
    ds_read_b64_tr_b16 a[136:137], v31 offset:8192
    ds_read_b64_tr_b16 a[138:139], v31 offset:8704
    buffer_load_dwordx4 v3, s[8:11], s57 offen offset:1024 lds
    v_mfma_f32_32x32x16_bf16 v[176:191], a[12:15], a[156:159], v[176:191]
    ds_read_b64_tr_b16 a[140:141], v35 offset:8192
    ds_read_b64_tr_b16 a[142:143], v35 offset:8704
    buffer_load_dwordx4 v4, s[8:11], s57 offen offset:2048 lds
    s_waitcnt lgkmcnt(5)
    v_mfma_f32_32x32x16_bf16 v[160:175], a[16:19], a[128:131], v[160:175]
    ds_read_b128 a[24:27], v24 offset:16384
    ds_read_b64_tr_b16 a[144:145], v32 offset:8192
    ds_read_b64_tr_b16 a[146:147], v32 offset:8704
    buffer_load_dwordx4 v5, s[8:11], s57 offen offset:3072 lds
    v_mfma_f32_32x32x16_bf16 v[176:191], a[16:19], a[132:135], v[176:191]
    ds_read_b64_tr_b16 a[148:149], v36 offset:8192
    ds_read_b64_tr_b16 a[150:151], v36 offset:8704
    s_add_u32 s96, s96, s60
    s_waitcnt lgkmcnt(5)
    v_mfma_f32_32x32x16_bf16 v[160:175], a[20:23], a[136:139], v[160:175]
    ds_read_b128 a[28:31], v25 offset:16384
    ds_read_b64_tr_b16 a[152:153], v33 offset:8192
    ds_read_b64_tr_b16 a[154:155], v33 offset:8704
    s_xor_b32 s58, s74, 3
    s_add_u32 m0, s61, 24576
    s_mul_i32 s58, s58, 196608
    buffer_load_dwordx4 v26, s[12:15], s58 offen lds
    v_mfma_f32_32x32x16_bf16 v[176:191], a[20:23], a[140:143], v[176:191]
    ds_read_b64_tr_b16 a[156:157], v37 offset:8192
    ds_read_b64_tr_b16 a[158:159], v37 offset:8704
    buffer_load_dwordx4 v27, s[12:15], s58 offen offset:1024 lds
    s_waitcnt lgkmcnt(5)
    v_mfma_f32_32x32x16_bf16 v[160:175], a[24:27], a[144:147], v[160:175]
    s_add_u32 m0, s60, 65536
    s_xor_b32 s57, s75, 512
    buffer_load_dwordx4 v2, s[8:11], s57 offen lds
    buffer_load_dwordx4 v3, s[8:11], s57 offen offset:1024 lds
    buffer_load_dwordx4 v4, s[8:11], s57 offen offset:2048 lds
    buffer_load_dwordx4 v5, s[8:11], s57 offen offset:3072 lds
    s_waitcnt vmcnt(12)
    s_waitcnt lgkmcnt(0)
    s_barrier
    ds_read_b128 a[32:35], v22 offset:32768
    ds_read_b64_tr_b16 a[128:129], v30 offset:16384
    ds_read_b64_tr_b16 a[130:131], v30 offset:16896
    s_xor_b32 s58, s74, 4
    s_add_u32 m0, s61, 0
    s_mul_i32 s58, s58, 196608
    buffer_load_dwordx4 v26, s[12:15], s58 offen lds
    v_xor_b32 v100, s96, v100
    v_xor_b32 v101, 64, v100
    v_add_u32 v102, 0x10000, v100
    v_mfma_f32_32x32x16_bf16 v[176:191], a[24:27], a[148:151], v[176:191]
    ds_read_b64_tr_b16 a[132:133], v34 offset:16384
    ds_read_b64_tr_b16 a[134:135], v34 offset:16896
    buffer_load_dwordx4 v27, s[12:15], s58 offen offset:1024 lds
    v_add_u32 v103, 0x10000, v101
    v_add_u32 v104, 0x10000, v102
    v_add_u32 v105, 0x10000, v103
    v_and_b32 v89, 0x1f0, v1
    v_add_u32 v89, 0, v89
    s_lshl_b32 s96, s52, 2
    v_mfma_f32_32x32x16_bf16 v[160:175], a[28:31], a[152:155], v[160:175]
    ds_read_b128 a[36:39], v23 offset:32768
    ds_read_b64_tr_b16 a[136:137], v31 offset:16384
    ds_read_b64_tr_b16 a[138:139], v31 offset:16896
    s_add_u32 m0, s60, 81920
    s_xor_b32 s57, s75, 640
    buffer_load_dwordx4 v2, s[8:11], s57 offen lds
    v_add_u32 v88, s96, v89
    s_and_b32 s96, s54, 14
    s_lshl_b32 s96, s96, 6
    s_add_u32 s96, s96, s56
    v_mfma_f32_32x32x16_bf16 v[176:191], a[28:31], a[156:159], v[176:191]
    ds_read_b64_tr_b16 a[140:141], v35 offset:16384
    ds_read_b64_tr_b16 a[142:143], v35 offset:16896
    buffer_load_dwordx4 v3, s[8:11], s57 offen offset:1024 lds
    s_lshl_b32 s70, s96, 12
    s_add_u32 s76, s70, 262144
    s_mul_i32 s71, s56, 147456
    s_add_u32 s71, s71, 6291456
    s_mov_b32 s78, 17825792
    v_lshrrev_b32 v136, 2, v0
    s_waitcnt lgkmcnt(5)
    v_mfma_f32_32x32x16_bf16 v[160:175], a[32:35], a[128:131], v[160:175]
    ds_read_b128 a[40:43], v24 offset:32768
    ds_read_b64_tr_b16 a[144:145], v32 offset:16384
    ds_read_b64_tr_b16 a[146:147], v32 offset:16896
    buffer_load_dword v109, v110, s[48:51], 0 offen sc1
    v_xor_b32 v136, v136, v0
    v_bfe_i32 v136, v136, 2, 1
    v_not_b32 v136, v136
    v_and_b32 v50, 0x3f803f80, v136
    v_and_b32 v51, 0x3f803f80, v136
    v_and_b32 v52, 0x3f803f80, v136
    v_mfma_f32_32x32x16_bf16 v[176:191], a[32:35], a[132:135], v[176:191]
    ds_read_b64_tr_b16 a[148:149], v36 offset:16384
    ds_read_b64_tr_b16 a[150:151], v36 offset:16896
    buffer_load_dwordx4 v4, s[8:11], s57 offen offset:2048 lds
    v_and_b32 v53, 0x3f803f80, v136
    v_and_b32 v38, 0xffff, v30
    v_and_b32 v39, 0xffff, v31
    v_and_b32 v40, 0xffff, v32
    v_and_b32 v41, 0xffff, v33
    v_and_b32 v42, 0xffff, v34
    s_waitcnt lgkmcnt(5)
    v_mfma_f32_32x32x16_bf16 v[160:175], a[36:39], a[136:139], v[160:175]
    ds_read_b128 a[44:47], v25 offset:32768
    ds_read_b64_tr_b16 a[152:153], v33 offset:16384
    ds_read_b64_tr_b16 a[154:155], v33 offset:16896
    buffer_load_dwordx4 v5, s[8:11], s57 offen offset:3072 lds
    v_mov_b32 v242, 0x3f803f80
    v_mov_b32 v236, 0
    v_mov_b32 v237, 0
    v_mov_b32 v238, 0
    v_mov_b32 v239, 0
    v_mov_b32 v240, 0
    v_mfma_f32_32x32x16_bf16 v[176:191], a[36:39], a[140:143], v[176:191]
    ds_read_b64_tr_b16 a[156:157], v37 offset:16384
    ds_read_b64_tr_b16 a[158:159], v37 offset:16896
    s_xor_b32 s58, s74, 5
    s_add_u32 m0, s61, 8192
    s_mul_i32 s58, s58, 196608
    buffer_load_dwordx4 v26, s[12:15], s58 offen lds
    v_mov_b32 v241, 0
    s_waitcnt vmcnt(19)
    v_dot2_f32_bf16 v236, v224, v242, v236
    v_dot2_f32_bf16 v237, v224, v224, v237
    v_dot2_f32_bf16 v238, v224, v232, v238
    s_waitcnt vmcnt(18)
    v_dot2_f32_bf16 v239, v228, v242, v239
    v_dot2_f32_bf16 v240, v228, v228, v240
    v_dot2_f32_bf16 v241, v228, v232, v241
    v_dot2_f32_bf16 v236, v225, v242, v236
    v_dot2_f32_bf16 v237, v225, v225, v237
    v_dot2_f32_bf16 v238, v225, v233, v238
    v_dot2_f32_bf16 v239, v229, v242, v239
    v_dot2_f32_bf16 v240, v229, v229, v240
    v_dot2_f32_bf16 v241, v229, v233, v241
    v_dot2_f32_bf16 v236, v226, v242, v236
    v_dot2_f32_bf16 v237, v226, v226, v237
    v_dot2_f32_bf16 v238, v226, v234, v238
    v_dot2_f32_bf16 v239, v230, v242, v239
    v_dot2_f32_bf16 v240, v230, v230, v240
    v_dot2_f32_bf16 v241, v230, v234, v241
    v_dot2_f32_bf16 v236, v227, v242, v236
    v_dot2_f32_bf16 v237, v227, v227, v237
    v_dot2_f32_bf16 v238, v227, v235, v238
    v_dot2_f32_bf16 v239, v231, v242, v239
    v_dot2_f32_bf16 v240, v231, v231, v240
    v_dot2_f32_bf16 v241, v231, v235, v241
    s_waitcnt lgkmcnt(5)
    v_mfma_f32_32x32x16_bf16 v[160:175], a[40:43], a[144:147], v[160:175]
    s_waitcnt vmcnt(12)
    s_waitcnt lgkmcnt(0)
    s_barrier
    ds_read_b128 a[48:51], v22 offset:49152
    ds_read_b64_tr_b16 a[128:129], v30 offset:24576
    ds_read_b64_tr_b16 a[130:131], v30 offset:25088
    buffer_load_dwordx4 v27, s[12:15], s58 offen offset:1024 lds
    v_permlane32_swap_b32 v236, v239
    v_permlane32_swap_b32 v237, v240
    v_permlane32_swap_b32 v238, v241
    v_add_f32 v236, v236, v239
    v_add_f32 v237, v237, v240
    v_add_f32 v238, v238, v241
    v_mfma_f32_32x32x16_bf16 v[176:191], a[40:43], a[148:151], v[176:191]
    ds_read_b64_tr_b16 a[132:133], v34 offset:24576
    ds_read_b64_tr_b16 a[134:135], v34 offset:25088
    s_add_u32 m0, s60, 98304
    s_xor_b32 s57, s75, 768
    buffer_load_dwordx4 v2, s[8:11], s57 offen lds
    v_add_f32_dpp v236, v236, v236 quad_perm:[1,0,3,2] row_mask:0xf bank_mask:0xf
    v_add_f32_dpp v237, v237, v237 quad_perm:[1,0,3,2] row_mask:0xf bank_mask:0xf
    v_add_f32_dpp v238, v238, v238 quad_perm:[1,0,3,2] row_mask:0xf bank_mask:0xf
    v_add_f32_dpp v236, v236, v236 quad_perm:[2,3,0,1] row_mask:0xf bank_mask:0xf
    v_mfma_f32_32x32x16_bf16 v[160:175], a[44:47], a[152:155], v[160:175]
    ds_read_b128 a[52:55], v23 offset:49152
    ds_read_b64_tr_b16 a[136:137], v31 offset:24576
    ds_read_b64_tr_b16 a[138:139], v31 offset:25088
    buffer_load_dwordx4 v3, s[8:11], s57 offen offset:1024 lds
    v_add_f32_dpp v237, v237, v237 quad_perm:[2,3,0,1] row_mask:0xf bank_mask:0xf
    v_add_f32_dpp v238, v238, v238 quad_perm:[2,3,0,1] row_mask:0xf bank_mask:0xf
    v_add_f32_dpp v236, v236, v236 row_half_mirror row_mask:0xf bank_mask:0xf
    v_add_f32_dpp v237, v237, v237 row_half_mirror row_mask:0xf bank_mask:0xf
    v_add_f32_dpp v238, v238, v238 row_half_mirror row_mask:0xf bank_mask:0xf
    v_add_f32_dpp v236, v236, v236 row_mirror row_mask:0xf bank_mask:0xf
    v_mfma_f32_32x32x16_bf16 v[176:191], a[44:47], a[156:159], v[176:191]
    ds_read_b64_tr_b16 a[140:141], v35 offset:24576
    ds_read_b64_tr_b16 a[142:143], v35 offset:25088
    buffer_load_dwordx4 v4, s[8:11], s57 offen offset:2048 lds
    v_add_f32_dpp v237, v237, v237 row_mirror row_mask:0xf bank_mask:0xf
    v_add_f32_dpp v238, v238, v238 row_mirror row_mask:0xf bank_mask:0xf
    v_mov_b32 v239, v236
    v_mov_b32 v240, v237
    v_mov_b32 v241, v238
    v_permlane16_swap_b32 v236, v239
    s_waitcnt lgkmcnt(5)
    v_mfma_f32_32x32x16_bf16 v[160:175], a[48:51], a[128:131], v[160:175]
    ds_read_b128 a[56:59], v24 offset:49152
    ds_read_b64_tr_b16 a[144:145], v32 offset:24576
    ds_read_b64_tr_b16 a[146:147], v32 offset:25088
    buffer_load_dwordx4 v5, s[8:11], s57 offen offset:3072 lds
    v_permlane16_swap_b32 v237, v240
    v_permlane16_swap_b32 v238, v241
    v_add_f32 v236, v236, v239
    v_add_f32 v237, v237, v240
    v_add_f32 v238, v238, v241
    v_mul_f32 v238, 0x3fb8aa3b, v238
    v_mfma_f32_32x32x16_bf16 v[176:191], a[48:51], a[132:135], v[176:191]
    ds_read_b64_tr_b16 a[148:149], v36 offset:24576
    ds_read_b64_tr_b16 a[150:151], v36 offset:25088
    s_xor_b32 s58, s74, 6
    s_add_u32 m0, s61, 16384
    s_mul_i32 s58, s58, 196608
    buffer_load_dwordx4 v26, s[12:15], s58 offen lds
    v_mul_f32 v244, 0xbb000000, v236
    v_min_f32 v238, 0x42b40000, v238
    v_mul_f32 v245, 0x3b000000, v237
    s_waitcnt lgkmcnt(5)
    v_mfma_f32_32x32x16_bf16 v[160:175], a[52:55], a[136:139], v[160:175]
    ds_read_b128 a[60:63], v25 offset:49152
    ds_read_b64_tr_b16 a[152:153], v33 offset:24576
    ds_read_b64_tr_b16 a[154:155], v33 offset:25088
    buffer_load_dwordx4 v27, s[12:15], s58 offen offset:1024 lds
    v_exp_f32 v246, v238
    v_fma_f32 v245, -v244, v244, v245
    v_max_f32 v245, 0, v245
    v_add_f32 v245, 0x3727c5ac, v245
    v_lshrrev_b32 v239, 5, v0
    v_mfma_f32_32x32x16_bf16 v[176:191], a[52:55], a[140:143], v[176:191]
    ds_read_b64_tr_b16 a[156:157], v37 offset:24576
    ds_read_b64_tr_b16 a[158:159], v37 offset:25088
    s_xor_b32 s58, s59, 0
    s_mul_i32 s58, s58, 229376
    s_add_u32 m0, s62, 0
    s_add_u32 s58, s58, s64
    buffer_load_dwordx4 v10, s[16:19], s58 offen lds
    v_lshlrev_b32 v239, 4, v239
    v_and_b32 v43, 0xffff, v35
    s_waitcnt lgkmcnt(5)
    v_mfma_f32_32x32x16_bf16 v[160:175], a[56:59], a[144:147], v[160:175]
    s_waitcnt vmcnt(14)
    s_waitcnt lgkmcnt(0)
    s_barrier
    ds_read_b128 a[64:67], v22 offset:0
    ds_read_b64_tr_b16 a[128:129], v30 offset:0
    ds_read_b64_tr_b16 a[130:131], v30 offset:512
    buffer_load_dwordx4 v11, s[16:19], s58 offen offset:1024 lds
    v_and_b32 v44, 0xffff, v36
    v_and_b32 v45, 0xffff, v37
    s_and_b32 s96, s54, 14
    s_lshl4_add_u32 s96, s53, s96
    s_lshl2_add_u32 s96, s96, s52
    s_lshl_b32 s96, s96, 7
    v_mfma_f32_32x32x16_bf16 v[176:191], a[56:59], a[148:151], v[176:191]
    ds_read_b64_tr_b16 a[132:133], v34 offset:0
    ds_read_b64_tr_b16 a[134:135], v34 offset:512
    buffer_load_dwordx4 v12, s[16:19], s58 offen offset:2048 lds
    s_and_b32 s97, s54, 1
    s_lshl2_add_u32 s96, s97, s96
    v_lshrrev_b32 v141, 1, v0
    v_mul_u32_u24 v141, 8200, v141
    v_and_b32 v142, 1, v0
    v_lshl_add_u32 v141, v142, 9, v141
    s_waitcnt vmcnt(13)
    v_cmp_eq_u32 vcc, 0, v109
    s_nop 0
    s_cbranch_vccnz L_EPY_S
L_EPY_R:
    v_mfma_f32_32x32x16_bf16 v[160:175], a[60:63], a[152:155], v[160:175]
    ds_read_b128 a[68:71], v23 offset:0
    ds_read_b64_tr_b16 a[136:137], v31 offset:0
    ds_read_b64_tr_b16 a[138:139], v31 offset:512
    buffer_load_dwordx4 v13, s[16:19], s58 offen offset:3072 lds
    v_mov_b32 v247, v109
    v_mfma_f32_32x32x16_bf16 v[176:191], a[60:63], a[156:159], v[176:191]
    ds_read_b64_tr_b16 a[140:141], v35 offset:0
    ds_read_b64_tr_b16 a[142:143], v35 offset:512
    s_lshl_b32 s100, s54, 5
    s_add_u32 s100, s100, s73
    s_mov_b32 exec_lo, 1
    s_mov_b32 exec_hi, 1
    buffer_store_dwordx4 v[244:247], v239, s[20:23], s100 offen sc1
    s_mov_b64 exec, -1
    v_add_u32 v106, s96, v141
    s_waitcnt lgkmcnt(5)
    v_mfma_f32_32x32x16_bf16 v[160:175], a[64:67], a[128:131], v[160:175]
    ds_read_b128 a[72:75], v24 offset:0
    ds_read_b64_tr_b16 a[144:145], v32 offset:0
    ds_read_b64_tr_b16 a[146:147], v32 offset:512
    s_add_u32 m0, s62, 4096
    s_add_u32 s58, s58, 114688
    buffer_load_dwordx4 v10, s[16:19], s58 offen lds
    s_lshr_b32 s96, s56, 1
    s_lshl_b32 s96, s96, 5
    s_lshr_b32 s97, s54, 2
    s_add_u32 s96, s96, s97
    v_mfma_f32_32x32x16_bf16 v[176:191], a[64:67], a[132:135], v[176:191]
    ds_read_b64_tr_b16 a[148:149], v36 offset:0
    ds_read_b64_tr_b16 a[150:151], v36 offset:512
    buffer_load_dwordx4 v11, s[16:19], s58 offen offset:1024 lds
    s_lshl_b32 s96, s96, 4
    s_and_b32 s97, s54, 3
    s_add_u32 s96, s96, s97
    s_and_b32 s97, s52, 1
    s_lshl1_add_u32 s96, s96, s97
    s_lshl_b32 s96, s96, 2
    s_waitcnt lgkmcnt(5)
    v_mfma_f32_32x32x16_bf16 v[160:175], a[68:71], a[136:139], v[160:175]
    ds_read_b128 a[76:79], v25 offset:0
    ds_read_b64_tr_b16 a[152:153], v33 offset:0
    ds_read_b64_tr_b16 a[154:155], v33 offset:512
    buffer_load_dwordx4 v12, s[16:19], s58 offen offset:2048 lds
    s_add_u32 s96, s96, 262144
    v_lshl_add_u32 v107, v0, 9, s96
    s_lshr_b32 s96, s56, 1
    s_andn2_b32 s96, s96, 4
    s_lshr_b32 s97, s54, 3
    s_lshl2_add_u32 s96, s97, s96
    v_mfma_f32_32x32x16_bf16 v[176:191], a[68:71], a[140:143], v[176:191]
    ds_read_b64_tr_b16 a[156:157], v37 offset:0
    ds_read_b64_tr_b16 a[158:159], v37 offset:512
    buffer_load_dwordx4 v13, s[16:19], s58 offen offset:3072 lds
    s_lshl_b32 s96, s96, 5
    s_bfe_u32 s97, s54, 0x20001
    s_add_u32 s96, s96, s97
    s_bfe_u32 s97, s56, 0x10003
    s_lshl3_add_u32 s96, s96, s97
    s_and_b32 s97, s54, 1
    s_waitcnt lgkmcnt(5)
    v_mfma_f32_32x32x16_bf16 v[160:175], a[72:75], a[144:147], v[160:175]
    s_waitcnt vmcnt(15)
    s_waitcnt lgkmcnt(0)
    s_barrier
    ds_read_b128 a[80:83], v22 offset:16384
    ds_read_b64_tr_b16 a[128:129], v30 offset:8192
    ds_read_b64_tr_b16 a[130:131], v30 offset:8704
    s_add_u32 m0, s60, 114688
    s_xor_b32 s57, s75, 896
    buffer_load_dwordx4 v2, s[8:11], s57 offen lds
    s_lshl1_add_u32 s96, s96, s97
    s_and_b32 s97, s52, 1
    s_lshl1_add_u32 s96, s96, s97
    s_lshl_b32 s96, s96, 2
    v_mfma_f32_32x32x16_bf16 v[176:191], a[72:75], a[148:151], v[176:191]
    ds_read_b64_tr_b16 a[132:133], v34 offset:8192
    ds_read_b64_tr_b16 a[134:135], v34 offset:8704
    buffer_load_dwordx4 v3, s[8:11], s57 offen offset:1024 lds
    s_add_u32 s96, s96, 262144
    v_lshl_add_u32 v87, v0, 9, s96
    s_lshl_b32 s96, s54, 6
    s_add_u32 s96, s96, s56
    s_or_b32 s77, s96, 64
    s_lshl_b32 s77, s77, 11
    v_mfma_f32_32x32x16_bf16 v[160:175], a[76:79], a[152:155], v[160:175]
    ds_read_b128 a[84:87], v23 offset:16384
    ds_read_b64_tr_b16 a[136:137], v31 offset:8192
    ds_read_b64_tr_b16 a[138:139], v31 offset:8704
    buffer_load_dwordx4 v4, s[8:11], s57 offen offset:2048 lds
    s_add_u32 s77, s77, 4194304
    s_lshl_b32 s93, s96, 12
    s_sub_u32 s92, s93, 16384
    s_sub_u32 s91, s93, 32768
    s_cmp_lt_u32 s53, 1
    s_cselect_b32 s92, 0, s92
    s_cselect_b32 s96, 0x40000000, 0
    v_mfma_f32_32x32x16_bf16 v[176:191], a[76:79], a[156:159], v[176:191]
    ds_read_b64_tr_b16 a[140:141], v35 offset:8192
    ds_read_b64_tr_b16 a[142:143], v35 offset:8704
    buffer_load_dwordx4 v5, s[8:11], s57 offen offset:3072 lds
    v_or_b32 v91, s96, v1
    s_cmp_lt_u32 s53, 2
    s_cselect_b32 s91, 0, s91
    s_cselect_b32 s96, 0x40000000, 0
    v_or_b32 v92, s96, v1
    s_mul_i32 s83, s52, 4128
    s_waitcnt lgkmcnt(5)
    v_mfma_f32_32x32x16_bf16 v[160:175], a[80:83], a[128:131], v[160:175]
    ds_read_b128 a[88:91], v24 offset:16384
    ds_read_b64_tr_b16 a[144:145], v32 offset:8192
    ds_read_b64_tr_b16 a[146:147], v32 offset:8704
    s_xor_b32 s58, s74, 7
    s_add_u32 m0, s61, 24576
    s_mul_i32 s58, s58, 196608
    buffer_load_dwordx4 v26, s[12:15], s58 offen lds
    s_add_u32 s83, s83, 2048
    v_lshrrev_b32 v141, 3, v0
    v_min_u32 v141, 2, v141
    v_mfma_f32_32x32x16_bf16 v[176:191], a[80:83], a[132:135], v[176:191]
    ds_read_b64_tr_b16 a[148:149], v36 offset:8192
    ds_read_b64_tr_b16 a[150:151], v36 offset:8704
    buffer_load_dwordx4 v27, s[12:15], s58 offen offset:1024 lds
    v_add_u32 v142, s53, v141
    v_cmp_le_u32 vcc, 2, v142
    v_mov_b32 v99, 0x3f803f80
    s_nop 0
    v_cndmask_b32 v99, 0, v99, vcc
    v_mul_u32_u24 v98, 16512, v141
    s_waitcnt lgkmcnt(5)
    v_mfma_f32_32x32x16_bf16 v[160:175], a[84:87], a[136:139], v[160:175]
    ds_read_b128 a[92:95], v25 offset:16384
    ds_read_b64_tr_b16 a[152:153], v33 offset:8192
    ds_read_b64_tr_b16 a[154:155], v33 offset:8704
    v_bfe_u32 v141, v0, 2, 1
    v_mul_u32_u24 v141, 1040, v141
    v_and_b32 v142, 3, v0
    v_lshl_add_u32 v141, v142, 2, v141
    v_add3_u32 v98, v98, v141, s83
    v_add_u32 v93, s83, v1
    v_and_b32 v141, 0x2f0, v1
    v_mfma_f32_32x32x16_bf16 v[176:191], a[84:87], a[140:143], v[176:191]
    ds_read_b64_tr_b16 a[156:157], v37 offset:8192
    ds_read_b64_tr_b16 a[158:159], v37 offset:8704
    v_add_u32 v142, 256, v141
    v_and_b32 v94, 16, v0
    v_cmp_eq_u32 vcc, 0, v94
    v_mov_b32 v94, 1024
    s_add_u32 s96, s83, 2048
    v_cndmask_b32 v141, v94, v141, vcc
    v_cndmask_b32 v142, v94, v142, vcc
    s_waitcnt lgkmcnt(5)
    v_mfma_f32_32x32x16_bf16 v[160:175], a[88:91], a[144:147], v[160:175]
    s_waitcnt vmcnt(6)
    s_waitcnt lgkmcnt(0)
    s_barrier
    ds_read_b128 a[96:99], v22 offset:32768
    ds_read_b64_tr_b16 a[128:129], v30 offset:16384
    ds_read_b64_tr_b16 a[130:131], v30 offset:16896
    ds_read_b64_tr_b16 a[132:133], v34 offset:16384
    ds_read_b64_tr_b16 a[134:135], v34 offset:16896
    v_add_u32 v94, s96, v141
    v_add_u32 v95, s96, v142
    s_mul_i32 s84, s80, 294912
    s_add_u32 s84, s84, 6291456
    s_add_u32 s85, s84, 147456
    v_mfma_f32_32x32x16_bf16 v[176:191], a[88:91], a[148:151], v[176:191]
    ds_read_b64_tr_b16 a[160:161], v38 offset:0
    ds_read_b64_tr_b16 a[162:163], v38 offset:512
    ds_read_b64_tr_b16 a[164:165], v42 offset:0
    ds_read_b64_tr_b16 a[166:167], v42 offset:512
    s_cmp_lt_u32 s52, 2
    s_cselect_b32 s96, s84, s85
    s_cselect_b32 s85, s85, s84
    s_lshl_b32 s97, s52, 13
    s_add_u32 s86, s96, s97
    v_mfma_f32_32x32x16_bf16 v[160:175], a[92:95], a[152:155], v[160:175]
    ds_read_b128 a[100:103], v23 offset:32768
    ds_read_b64_tr_b16 a[136:137], v31 offset:16384
    ds_read_b64_tr_b16 a[138:139], v31 offset:16896
    ds_read_b64_tr_b16 a[140:141], v35 offset:16384
    ds_read_b64_tr_b16 a[142:143], v35 offset:16896
    s_add_u32 s86, s86, 114688
    s_and_b32 s97, s80, 4
    s_add_u32 s97, s97, s52
    s_mul_i32 s97, s97, 14336
    s_add_u32 s84, s96, s97
    v_mfma_f32_32x32x16_bf16 v[176:191], a[92:95], a[156:159], v[176:191]
    ds_read_b64_tr_b16 a[168:169], v39 offset:0
    ds_read_b64_tr_b16 a[170:171], v39 offset:512
    ds_read_b64_tr_b16 a[172:173], v43 offset:0
    ds_read_b64_tr_b16 a[174:175], v43 offset:512
    s_add_u32 s85, s85, s97
    s_and_b32 s88, s52, 1
    s_lshl1_add_u32 s88, s81, s88
    s_lshl_b32 s88, s88, 6
    v_lshrrev_b32 v143, 5, v0
    s_waitcnt lgkmcnt(9)
    v_mfma_f32_32x32x16_bf16 v[160:175], a[96:99], a[128:131], v[160:175]
    ds_read_b128 a[104:107], v24 offset:32768
    ds_read_b64_tr_b16 a[144:145], v32 offset:16384
    ds_read_b64_tr_b16 a[146:147], v32 offset:16896
    s_xor_b32 s58, s59, 4
    s_mul_i32 s58, s58, 229376
    s_add_u32 m0, s62, 32768
    s_add_u32 s58, s58, s64
    buffer_load_dwordx4 v10, s[16:19], s58 offen lds
    v_mfma_f32_32x32x16_bf16 v[176:191], a[96:99], a[132:135], v[176:191]
    ds_read_b64_tr_b16 a[148:149], v36 offset:16384
    ds_read_b64_tr_b16 a[150:151], v36 offset:16896
    ds_read_b64_tr_b16 a[176:177], v40 offset:0
    buffer_load_dwordx4 v11, s[16:19], s58 offen offset:1024 lds
    v_lshlrev_b32 v143, 2, v143
    v_mfma_f32_32x32x16_bf16 v[192:207], a[160:163], a[0:3], 0
    ds_read_b64_tr_b16 a[178:179], v40 offset:512
    ds_read_b64_tr_b16 a[180:181], v44 offset:0
    ds_read_b64_tr_b16 a[182:183], v44 offset:512
    v_and_b32 v112, 31, v0
    v_sub_u32 v143, v112, v143
    v_mfma_f32_32x32x16_bf16 v[208:223], a[164:167], a[0:3], 0
    buffer_load_dwordx4 v12, s[16:19], s58 offen offset:2048 lds
    v_add_u32 v143, 1, v143
    v_med3_i32 v143, v143, 0, 31
    v_lshlrev_b32 v143, v143, -1
    v_mfma_f32_16x16x32_bf16 v[66:69], v[50:53], a[160:163], 0
    v_mfma_f32_16x16x32_bf16 v[70:73], v[50:53], a[164:167], 0
    s_waitcnt lgkmcnt(9)
    v_mfma_f32_32x32x16_bf16 v[160:175], a[100:103], a[136:139], v[160:175]
    ds_read_b128 a[108:111], v25 offset:32768
    ds_read_b64_tr_b16 a[152:153], v33 offset:16384
    ds_read_b64_tr_b16 a[154:155], v33 offset:16896
    buffer_load_dwordx4 v13, s[16:19], s58 offen offset:3072 lds
    v_bfe_i32 v112, v143, 0, 1
    v_mfma_f32_32x32x16_bf16 v[176:191], a[100:103], a[140:143], v[176:191]
    ds_read_b64_tr_b16 a[156:157], v37 offset:16384
    ds_read_b64_tr_b16 a[158:159], v37 offset:16896
    ds_read_b64_tr_b16 a[184:185], v41 offset:0
    s_add_u32 m0, s62, 36864
    s_add_u32 s58, s58, 114688
    buffer_load_dwordx4 v10, s[16:19], s58 offen lds
    v_mfma_f32_32x32x16_bf16 v[192:207], a[168:171], a[4:7], v[192:207]
    ds_read_b64_tr_b16 a[186:187], v41 offset:512
    ds_read_b64_tr_b16 a[188:189], v45 offset:0
    ds_read_b64_tr_b16 a[190:191], v45 offset:512
    v_bfe_i32 v113, v143, 1, 1
    v_bfe_i32 v114, v143, 2, 1
    v_mfma_f32_32x32x16_bf16 v[208:223], a[172:175], a[4:7], v[208:223]
    buffer_load_dwordx4 v11, s[16:19], s58 offen offset:1024 lds
    v_bfe_i32 v115, v143, 3, 1
    v_bfe_i32 v116, v143, 8, 1
    v_bfe_i32 v117, v143, 9, 1
    s_waitcnt lgkmcnt(9)
    v_mfma_f32_32x32x16_bf16 v[160:175], a[104:107], a[144:147], v[160:175]
    s_waitcnt vmcnt(6)
    s_waitcnt lgkmcnt(0)
    s_barrier
    ds_read_b128 a[112:115], v22 offset:49152
    ds_read_b64_tr_b16 a[128:129], v30 offset:24576
    ds_read_b64_tr_b16 a[130:131], v30 offset:25088
    v_bfe_i32 v118, v143, 10, 1
    v_bfe_i32 v119, v143, 11, 1
    v_mfma_f32_32x32x16_bf16 v[176:191], a[104:107], a[148:151], v[176:191]
    ds_read_b64_tr_b16 a[132:133], v34 offset:24576
    ds_read_b64_tr_b16 a[134:135], v34 offset:25088
    ds_read_b64_tr_b16 a[160:161], v38 offset:8192
    buffer_load_dwordx4 v12, s[16:19], s58 offen offset:2048 lds
    v_bfe_i32 v120, v143, 16, 1
    v_mfma_f32_32x32x16_bf16 v[192:207], a[176:179], a[8:11], v[192:207]
    ds_read_b64_tr_b16 a[162:163], v38 offset:8704
    ds_read_b64_tr_b16 a[164:165], v42 offset:8192
    ds_read_b64_tr_b16 a[166:167], v42 offset:8704
    buffer_load_dwordx4 v13, s[16:19], s58 offen offset:3072 lds
    v_bfe_i32 v121, v143, 17, 1
    v_mfma_f32_32x32x16_bf16 v[208:223], a[180:183], a[8:11], v[208:223]
    v_bfe_i32 v122, v143, 18, 1
    v_bfe_i32 v123, v143, 19, 1
    v_bfe_i32 v124, v143, 24, 1
    v_bfe_i32 v125, v143, 25, 1
    v_mfma_f32_32x32x16_bf16 v[160:175], a[108:111], a[152:155], v[160:175]
    ds_read_b128 a[116:119], v23 offset:49152
    ds_read_b64_tr_b16 a[136:137], v31 offset:24576
    ds_read_b64_tr_b16 a[138:139], v31 offset:25088
    s_xor_b32 s58, s59, 0
    s_mul_i32 s58, s58, 229376
    s_add_u32 m0, s62, 65536
    s_add_u32 s58, s58, s63
    buffer_load_dwordx4 v10, s[16:19], s58 offen lds
    v_mfma_f32_32x32x16_bf16 v[176:191], a[108:111], a[156:159], v[176:191]
    ds_read_b64_tr_b16 a[140:141], v35 offset:24576
    ds_read_b64_tr_b16 a[142:143], v35 offset:25088
    ds_read_b64_tr_b16 a[168:169], v39 offset:8192
    buffer_load_dwordx4 v11, s[16:19], s58 offen offset:1024 lds
    v_bfe_i32 v126, v143, 26, 1
    v_mfma_f32_32x32x16_bf16 v[192:207], a[184:187], a[12:15], v[192:207]
    ds_read_b64_tr_b16 a[170:171], v39 offset:8704
    ds_read_b64_tr_b16 a[172:173], v43 offset:8192
    ds_read_b64_tr_b16 a[174:175], v43 offset:8704
    v_bfe_i32 v127, v143, 27, 1
    v_perm_b32 v128, v113, v112, s72
    v_mfma_f32_32x32x16_bf16 v[208:223], a[188:191], a[12:15], v[208:223]
    buffer_load_dwordx4 v12, s[16:19], s58 offen offset:2048 lds
    v_perm_b32 v129, v115, v114, s72
    v_perm_b32 v130, v117, v116, s72
    v_perm_b32 v131, v119, v118, s72
    s_waitcnt lgkmcnt(9)
    v_mfma_f32_32x32x16_bf16 v[160:175], a[112:115], a[128:131], v[160:175]
    ds_read_b128 a[120:123], v24 offset:49152
    ds_read_b64_tr_b16 a[144:145], v32 offset:24576
    ds_read_b64_tr_b16 a[146:147], v32 offset:25088
    v_perm_b32 v132, v121, v120, s72
    v_perm_b32 v133, v123, v122, s72
    v_mfma_f32_32x32x16_bf16 v[176:191], a[112:115], a[132:135], v[176:191]
    ds_read_b64_tr_b16 a[148:149], v36 offset:24576
    ds_read_b64_tr_b16 a[150:151], v36 offset:25088
    ds_read_b64_tr_b16 a[176:177], v40 offset:8192
    buffer_load_dwordx4 v13, s[16:19], s58 offen offset:3072 lds
    v_perm_b32 v134, v125, v124, s72
    v_mfma_f32_32x32x16_bf16 v[192:207], a[160:163], a[16:19], v[192:207]
    ds_read_b64_tr_b16 a[178:179], v40 offset:8704
    ds_read_b64_tr_b16 a[180:181], v44 offset:8192
    ds_read_b64_tr_b16 a[182:183], v44 offset:8704
    v_perm_b32 v135, v127, v126, s72
    s_add_u32 s24, s20, s55
    s_addc_u32 s25, s21, 0
    v_mfma_f32_32x32x16_bf16 v[208:223], a[164:167], a[16:19], v[208:223]
    s_add_u32 m0, s62, 69632
    s_add_u32 s58, s58, 114688
    buffer_load_dwordx4 v10, s[16:19], s58 offen lds
    s_add_u32 s26, s20, s90
    s_addc_u32 s27, s21, 0
    v_mfma_f32_16x16x32_bf16 v[66:69], v[50:53], a[160:163], v[66:69]
    v_mfma_f32_16x16x32_bf16 v[70:73], v[50:53], a[164:167], v[70:73]
    s_waitcnt lgkmcnt(9)
    v_mfma_f32_32x32x16_bf16 v[160:175], a[116:119], a[136:139], v[160:175]
    ds_read_b128 a[124:127], v25 offset:49152
    ds_read_b64_tr_b16 a[152:153], v33 offset:24576
    ds_read_b64_tr_b16 a[154:155], v33 offset:25088
    buffer_load_dwordx4 v11, s[16:19], s58 offen offset:1024 lds
    v_readfirstlane_b32 s28, v109
    v_mfma_f32_32x32x16_bf16 v[176:191], a[116:119], a[140:143], v[176:191]
    ds_read_b64_tr_b16 a[156:157], v37 offset:24576
    ds_read_b64_tr_b16 a[158:159], v37 offset:25088
    ds_read_b64_tr_b16 a[184:185], v41 offset:8192
    buffer_load_dwordx4 v12, s[16:19], s58 offen offset:2048 lds
    v_readfirstlane_b32 s29, v109
    v_mfma_f32_32x32x16_bf16 v[192:207], a[168:171], a[20:23], v[192:207]
    ds_read_b64_tr_b16 a[186:187], v41 offset:8704
    ds_read_b64_tr_b16 a[188:189], v45 offset:8192
    ds_read_b64_tr_b16 a[190:191], v45 offset:8704
    v_mfma_f32_32x32x16_bf16 v[208:223], a[172:175], a[20:23], v[208:223]
    buffer_load_dwordx4 v13, s[16:19], s58 offen offset:3072 lds
    s_waitcnt lgkmcnt(9)
    v_mfma_f32_32x32x16_bf16 v[160:175], a[120:123], a[144:147], v[160:175]
    s_waitcnt lgkmcnt(0)
    s_barrier
    ds_read_b64_tr_b16 a[160:161], v38 offset:16384
    ds_read_b64_tr_b16 a[162:163], v38 offset:16896
    ds_read_b64_tr_b16 a[164:165], v42 offset:16384
    v_mfma_f32_32x32x16_bf16 v[176:191], a[120:123], a[148:151], v[176:191]
    ds_read_b64_tr_b16 a[166:167], v42 offset:16896
    v_mfma_f32_32x32x16_bf16 v[192:207], a[176:179], a[24:27], v[192:207]
    v_mfma_f32_32x32x16_bf16 v[208:223], a[180:183], a[24:27], v[208:223]
    v_mfma_f32_32x32x16_bf16 v[160:175], a[124:127], a[152:155], v[160:175]
    ds_read_b64_tr_b16 a[168:169], v39 offset:16384
    ds_read_b64_tr_b16 a[170:171], v39 offset:16896
    ds_read_b64_tr_b16 a[172:173], v43 offset:16384
    v_mfma_f32_32x32x16_bf16 v[176:191], a[124:127], a[156:159], v[176:191]
    ds_read_b64_tr_b16 a[174:175], v43 offset:16896
    v_mfma_f32_32x32x16_bf16 v[192:207], a[184:187], a[28:31], v[192:207]
    v_mfma_f32_32x32x16_bf16 v[208:223], a[188:191], a[28:31], v[208:223]
    ds_read_b64_tr_b16 a[176:177], v40 offset:16384
    ds_read_b64_tr_b16 a[178:179], v40 offset:16896
    ds_read_b64_tr_b16 a[180:181], v44 offset:16384
    ds_read_b64_tr_b16 a[182:183], v44 offset:16896
    s_waitcnt lgkmcnt(8)
    v_mfma_f32_32x32x16_bf16 v[192:207], a[160:163], a[32:35], v[192:207]
    ds_read_b64_tr_b16 a[184:185], v41 offset:16384
    ds_read_b64_tr_b16 a[186:187], v41 offset:16896
    v_cvt_pk_bf16_f32 v160, v160, v161
    v_cvt_pk_bf16_f32 v161, v162, v163
    v_cvt_pk_bf16_f32 v162, v164, v165
    v_mfma_f32_32x32x16_bf16 v[208:223], a[164:167], a[32:35], v[208:223]
    ds_read_b64_tr_b16 a[188:189], v45 offset:16384
    ds_read_b64_tr_b16 a[190:191], v45 offset:16896
    v_cvt_pk_bf16_f32 v163, v166, v167
    v_cvt_pk_bf16_f32 v164, v168, v169
    v_mfma_f32_16x16x32_bf16 v[66:69], v[50:53], a[160:163], v[66:69]
    v_mfma_f32_16x16x32_bf16 v[70:73], v[50:53], a[164:167], v[70:73]
    s_waitcnt lgkmcnt(8)
    v_mfma_f32_32x32x16_bf16 v[192:207], a[168:171], a[36:39], v[192:207]
    ds_read_b64_tr_b16 a[160:161], v38 offset:24576
    ds_read_b64_tr_b16 a[162:163], v38 offset:25088
    v_cvt_pk_bf16_f32 v165, v170, v171
    v_cvt_pk_bf16_f32 v166, v172, v173
    v_cvt_pk_bf16_f32 v167, v174, v175
    v_mfma_f32_32x32x16_bf16 v[208:223], a[172:175], a[36:39], v[208:223]
    ds_read_b64_tr_b16 a[164:165], v42 offset:24576
    ds_read_b64_tr_b16 a[166:167], v42 offset:25088
    buffer_store_dwordx4 v[160:163], v1, s[20:23], s70 offen offset:2048 sc1
    v_cvt_pk_bf16_f32 v176, v176, v177
    s_waitcnt lgkmcnt(8)
    v_mfma_f32_32x32x16_bf16 v[192:207], a[176:179], a[40:43], v[192:207]
    ds_read_b64_tr_b16 a[168:169], v39 offset:24576
    ds_read_b64_tr_b16 a[170:171], v39 offset:25088
    v_cvt_pk_bf16_f32 v177, v178, v179
    v_cvt_pk_bf16_f32 v178, v180, v181
    v_cvt_pk_bf16_f32 v179, v182, v183
    v_mfma_f32_32x32x16_bf16 v[208:223], a[180:183], a[40:43], v[208:223]
    ds_read_b64_tr_b16 a[172:173], v43 offset:24576
    ds_read_b64_tr_b16 a[174:175], v43 offset:25088
    v_cvt_pk_bf16_f32 v180, v184, v185
    v_cvt_pk_bf16_f32 v181, v186, v187
    s_waitcnt lgkmcnt(8)
    v_mfma_f32_32x32x16_bf16 v[192:207], a[184:187], a[44:47], v[192:207]
    ds_read_b64_tr_b16 a[176:177], v40 offset:24576
    ds_read_b64_tr_b16 a[178:179], v40 offset:25088
    buffer_store_dwordx4 v[164:167], v1, s[20:23], s70 offen offset:3072 sc1
    v_cvt_pk_bf16_f32 v182, v188, v189
    v_cvt_pk_bf16_f32 v183, v190, v191
    v_mfma_f32_32x32x16_bf16 v[208:223], a[188:191], a[44:47], v[208:223]
    ds_read_b64_tr_b16 a[180:181], v44 offset:24576
    ds_read_b64_tr_b16 a[182:183], v44 offset:25088
    v_add_u32 v30, 0x10000, v38
    v_add_u32 v31, 0x10000, v39
    s_waitcnt lgkmcnt(8)
    v_mfma_f32_32x32x16_bf16 v[192:207], a[160:163], a[48:51], v[192:207]
    ds_read_b64_tr_b16 a[184:185], v41 offset:24576
    ds_read_b64_tr_b16 a[186:187], v41 offset:25088
    v_add_u32 v32, 0x10000, v40
    v_add_u32 v33, 0x10000, v41
    v_add_u32 v34, 0x10000, v42
    v_mfma_f32_32x32x16_bf16 v[208:223], a[164:167], a[48:51], v[208:223]
    ds_read_b64_tr_b16 a[188:189], v45 offset:24576
    ds_read_b64_tr_b16 a[190:191], v45 offset:25088
    buffer_store_dwordx4 v[176:179], v1, s[20:23], s76 offen offset:2048 sc1
    v_add_u32 v35, 0x10000, v43
    v_mfma_f32_16x16x32_bf16 v[66:69], v[50:53], a[160:163], v[66:69]
    v_mfma_f32_16x16x32_bf16 v[70:73], v[50:53], a[164:167], v[70:73]
    s_waitcnt lgkmcnt(8)
    v_mfma_f32_32x32x16_bf16 v[192:207], a[168:171], a[52:55], v[192:207]
    s_waitcnt vmcnt(11)
    s_waitcnt lgkmcnt(0)
    s_barrier
    ds_read_b64_tr_b16 a[160:161], v38 offset:32768
    ds_read_b64_tr_b16 a[162:163], v38 offset:33280
    v_add_u32 v36, 0x10000, v44
    v_add_u32 v37, 0x10000, v45
    s_mov_b32 s61, 0x6325410
    v_mfma_f32_32x32x16_bf16 v[208:223], a[172:175], a[52:55], v[208:223]
    ds_read_b64_tr_b16 a[164:165], v42 offset:32768
    ds_read_b64_tr_b16 a[166:167], v42 offset:33280
    buffer_store_dwordx4 v[180:183], v1, s[20:23], s76 offen offset:3072 sc1
    s_bitcmp1_b32 s52, 0
    s_cselect_b32 s61, 0x0654321, s61
    v_mfma_f32_32x32x16_bf16 v[192:207], a[176:179], a[56:59], v[192:207]
    ds_read_b64_tr_b16 a[168:169], v39 offset:32768
    ds_read_b64_tr_b16 a[170:171], v39 offset:33280
    s_mov_b32 s75, 1179648
    s_bitcmp1_b32 s80, 2
    s_cselect_b32 s75, 4293787648, s75
    v_mfma_f32_32x32x16_bf16 v[208:223], a[180:183], a[56:59], v[208:223]
    ds_read_b64_tr_b16 a[172:173], v43 offset:32768
    ds_read_b64_tr_b16 a[174:175], v43 offset:33280
    v_mfma_f32_32x32x16_bf16 v[192:207], a[184:187], a[60:63], v[192:207]
    ds_read_b64_tr_b16 a[176:177], v40 offset:32768
    ds_read_b64_tr_b16 a[178:179], v40 offset:33280
    s_xor_b32 s58, s59, 4
    s_mul_i32 s58, s58, 229376
    s_add_u32 m0, s62, 98304
    s_add_u32 s58, s58, s63
    buffer_load_dwordx4 v10, s[16:19], s58 offen lds
    v_mfma_f32_32x32x16_bf16 v[208:223], a[188:191], a[60:63], v[208:223]
    ds_read_b64_tr_b16 a[180:181], v44 offset:32768
    ds_read_b64_tr_b16 a[182:183], v44 offset:33280
    s_waitcnt lgkmcnt(8)
    v_mfma_f32_32x32x16_bf16 v[192:207], a[160:163], a[64:67], v[192:207]
    ds_read_b64_tr_b16 a[184:185], v41 offset:32768
    ds_read_b64_tr_b16 a[186:187], v41 offset:33280
    buffer_load_dwordx4 v11, s[16:19], s58 offen offset:1024 lds
    v_mfma_f32_32x32x16_bf16 v[208:223], a[164:167], a[64:67], v[208:223]
    ds_read_b64_tr_b16 a[188:189], v45 offset:32768
    ds_read_b64_tr_b16 a[190:191], v45 offset:33280
    v_mfma_f32_16x16x32_bf16 v[66:69], v[50:53], a[160:163], v[66:69]
    v_mfma_f32_16x16x32_bf16 v[70:73], v[50:53], a[164:167], v[70:73]
    s_waitcnt lgkmcnt(8)
    v_mfma_f32_32x32x16_bf16 v[192:207], a[168:171], a[68:71], v[192:207]
    ds_read_b64_tr_b16 a[160:161], v38 offset:40960
    ds_read_b64_tr_b16 a[162:163], v38 offset:41472
    buffer_load_dwordx4 v[74:77], v108, s[20:23], s73 offen sc1
    v_mfma_f32_32x32x16_bf16 v[208:223], a[172:175], a[68:71], v[208:223]
    ds_read_b64_tr_b16 a[164:165], v42 offset:40960
    ds_read_b64_tr_b16 a[166:167], v42 offset:41472
    s_waitcnt lgkmcnt(8)
    v_mfma_f32_32x32x16_bf16 v[192:207], a[176:179], a[72:75], v[192:207]
    ds_read_b64_tr_b16 a[168:169], v39 offset:40960
    ds_read_b64_tr_b16 a[170:171], v39 offset:41472
    buffer_load_dwordx4 v12, s[16:19], s58 offen offset:2048 lds
    v_mfma_f32_32x32x16_bf16 v[208:223], a[180:183], a[72:75], v[208:223]
    ds_read_b64_tr_b16 a[172:173], v43 offset:40960
    ds_read_b64_tr_b16 a[174:175], v43 offset:41472
    s_waitcnt lgkmcnt(8)
    v_mfma_f32_32x32x16_bf16 v[192:207], a[184:187], a[76:79], v[192:207]
    ds_read_b64_tr_b16 a[176:177], v40 offset:40960
    ds_read_b64_tr_b16 a[178:179], v40 offset:41472
    buffer_load_dwordx4 v13, s[16:19], s58 offen offset:3072 lds
    v_mfma_f32_32x32x16_bf16 v[208:223], a[188:191], a[76:79], v[208:223]
    ds_read_b64_tr_b16 a[180:181], v44 offset:40960
    ds_read_b64_tr_b16 a[182:183], v44 offset:41472
    s_waitcnt lgkmcnt(8)
    v_mfma_f32_32x32x16_bf16 v[192:207], a[160:163], a[80:83], v[192:207]
    ds_read_b64_tr_b16 a[184:185], v41 offset:40960
    ds_read_b64_tr_b16 a[186:187], v41 offset:41472
    s_add_u32 m0, s62, 102400
    s_add_u32 s58, s58, 114688
    buffer_load_dwordx4 v10, s[16:19], s58 offen lds
    v_mfma_f32_32x32x16_bf16 v[208:223], a[164:167], a[80:83], v[208:223]
    ds_read_b64_tr_b16 a[188:189], v45 offset:40960
    ds_read_b64_tr_b16 a[190:191], v45 offset:41472
    v_mfma_f32_16x16x32_bf16 v[66:69], v[50:53], a[160:163], v[66:69]
    v_mfma_f32_16x16x32_bf16 v[70:73], v[50:53], a[164:167], v[70:73]
    s_waitcnt lgkmcnt(8)
    v_mfma_f32_32x32x16_bf16 v[192:207], a[168:171], a[84:87], v[192:207]
    ds_read_b64_tr_b16 a[160:161], v38 offset:49152
    ds_read_b64_tr_b16 a[162:163], v38 offset:49664
    buffer_load_dwordx4 v11, s[16:19], s58 offen offset:1024 lds
    v_mfma_f32_32x32x16_bf16 v[208:223], a[172:175], a[84:87], v[208:223]
    ds_read_b64_tr_b16 a[164:165], v42 offset:49152
    ds_read_b64_tr_b16 a[166:167], v42 offset:49664
    s_waitcnt lgkmcnt(8)
    v_mfma_f32_32x32x16_bf16 v[192:207], a[176:179], a[88:91], v[192:207]
    ds_read_b64_tr_b16 a[168:169], v39 offset:49152
    ds_read_b64_tr_b16 a[170:171], v39 offset:49664
    buffer_load_dwordx4 v12, s[16:19], s58 offen offset:2048 lds
    v_mfma_f32_32x32x16_bf16 v[208:223], a[180:183], a[88:91], v[208:223]
    ds_read_b64_tr_b16 a[172:173], v43 offset:49152
    ds_read_b64_tr_b16 a[174:175], v43 offset:49664
    s_waitcnt lgkmcnt(8)
    v_mfma_f32_32x32x16_bf16 v[192:207], a[184:187], a[92:95], v[192:207]
    ds_read_b64_tr_b16 a[176:177], v40 offset:49152
    ds_read_b64_tr_b16 a[178:179], v40 offset:49664
    buffer_load_dwordx4 v13, s[16:19], s58 offen offset:3072 lds
    v_mfma_f32_32x32x16_bf16 v[208:223], a[188:191], a[92:95], v[208:223]
    ds_read_b64_tr_b16 a[180:181], v44 offset:49152
    ds_read_b64_tr_b16 a[182:183], v44 offset:49664
    s_waitcnt lgkmcnt(8)
    v_mfma_f32_32x32x16_bf16 v[192:207], a[160:163], a[96:99], v[192:207]
    ds_read_b64_tr_b16 a[184:185], v41 offset:49152
    ds_read_b64_tr_b16 a[186:187], v41 offset:49664
    v_mfma_f32_32x32x16_bf16 v[208:223], a[164:167], a[96:99], v[208:223]
    ds_read_b64_tr_b16 a[188:189], v45 offset:49152
    ds_read_b64_tr_b16 a[190:191], v45 offset:49664
    v_mfma_f32_16x16x32_bf16 v[66:69], v[50:53], a[160:163], v[66:69]
    v_mfma_f32_16x16x32_bf16 v[70:73], v[50:53], a[164:167], v[70:73]
    s_waitcnt lgkmcnt(8)
    v_mfma_f32_32x32x16_bf16 v[192:207], a[168:171], a[100:103], v[192:207]
    ds_read_b64_tr_b16 a[160:161], v38 offset:57344
    ds_read_b64_tr_b16 a[162:163], v38 offset:57856
    v_mfma_f32_32x32x16_bf16 v[208:223], a[172:175], a[100:103], v[208:223]
    ds_read_b64_tr_b16 a[164:165], v42 offset:57344
    ds_read_b64_tr_b16 a[166:167], v42 offset:57856
    s_waitcnt lgkmcnt(8)
    v_mfma_f32_32x32x16_bf16 v[192:207], a[176:179], a[104:107], v[192:207]
    ds_read_b64_tr_b16 a[168:169], v39 offset:57344
    ds_read_b64_tr_b16 a[170:171], v39 offset:57856
    v_mfma_f32_32x32x16_bf16 v[208:223], a[180:183], a[104:107], v[208:223]
    ds_read_b64_tr_b16 a[172:173], v43 offset:57344
    ds_read_b64_tr_b16 a[174:175], v43 offset:57856
    s_waitcnt lgkmcnt(8)
    v_mfma_f32_32x32x16_bf16 v[192:207], a[184:187], a[108:111], v[192:207]
    ds_read_b64_tr_b16 a[176:177], v40 offset:57344
    ds_read_b64_tr_b16 a[178:179], v40 offset:57856
    v_mfma_f32_32x32x16_bf16 v[208:223], a[188:191], a[108:111], v[208:223]
    ds_read_b64_tr_b16 a[180:181], v44 offset:57344
    ds_read_b64_tr_b16 a[182:183], v44 offset:57856
    s_waitcnt lgkmcnt(8)
    v_mfma_f32_32x32x16_bf16 v[192:207], a[160:163], a[112:115], v[192:207]
    ds_read_b64_tr_b16 a[184:185], v41 offset:57344
    ds_read_b64_tr_b16 a[186:187], v41 offset:57856
    v_mfma_f32_32x32x16_bf16 v[208:223], a[164:167], a[112:115], v[208:223]
    ds_read_b64_tr_b16 a[188:189], v45 offset:57344
    ds_read_b64_tr_b16 a[190:191], v45 offset:57856
    v_mfma_f32_16x16x32_bf16 v[66:69], v[50:53], a[160:163], v[66:69]
    v_mfma_f32_16x16x32_bf16 v[70:73], v[50:53], a[164:167], v[70:73]
    s_waitcnt lgkmcnt(8)
    v_mfma_f32_32x32x16_bf16 v[192:207], a[168:171], a[116:119], v[192:207]
    s_waitcnt vmcnt(13)
    s_waitcnt lgkmcnt(0)
    s_barrier
    ds_read_b64_tr_b16 a[128:129], v30 offset:0
    ds_read_b64_tr_b16 a[130:131], v30 offset:512
    v_mfma_f32_32x32x16_bf16 v[208:223], a[172:175], a[116:119], v[208:223]
    ds_read_b64_tr_b16 a[132:133], v34 offset:0
    ds_read_b64_tr_b16 a[134:135], v34 offset:512
    v_mfma_f32_32x32x16_bf16 v[192:207], a[176:179], a[120:123], v[192:207]
    ds_read_b64_tr_b16 a[136:137], v31 offset:0
    ds_read_b64_tr_b16 a[138:139], v31 offset:512
    s_lshr_b32 s98, s54, 1
    s_lshl3_add_u32 s98, s56, s98
    s_mul_i32 s99, s98, 3584
    buffer_load_dword a250, v97, s[32:35], s99 offen
    s_lshl_b32 s99, s98, 10
    buffer_load_dword a249, v96, s[36:39], s99 offen
    v_mfma_f32_32x32x16_bf16 v[208:223], a[180:183], a[120:123], v[208:223]
    ds_read_b64_tr_b16 a[140:141], v35 offset:0
    ds_read_b64_tr_b16 a[142:143], v35 offset:512
    v_mfma_f32_32x32x16_bf16 v[192:207], a[184:187], a[124:127], v[192:207]
    ds_read_b64_tr_b16 a[144:145], v32 offset:0
    ds_read_b64_tr_b16 a[146:147], v32 offset:512
    v_mfma_f32_32x32x16_bf16 v[208:223], a[188:191], a[124:127], v[208:223]
    ds_read_b64_tr_b16 a[148:149], v36 offset:0
    ds_read_b64_tr_b16 a[150:151], v36 offset:512
    s_waitcnt lgkmcnt(8)
    v_mfma_f32_32x32x16_bf16 v[224:239], a[128:131], a[0:3], 0
    ds_read_b64_tr_b16 a[152:153], v33 offset:0
    ds_read_b64_tr_b16 a[154:155], v33 offset:512
    s_waitcnt vmcnt(11)
    s_mov_b64 exec, 63
    buffer_store_dword v109, v106, s[20:23], s78 offen sc1
    s_mov_b64 exec, -1
    v_mfma_f32_32x32x16_bf16 v[240:255], a[132:135], a[0:3], 0
    ds_read_b64_tr_b16 a[156:157], v37 offset:0
    ds_read_b64_tr_b16 a[158:159], v37 offset:512
    s_waitcnt vmcnt(9)
    v_cmp_ne_u32 vcc, v109, v77
    s_nop 0
    s_cbranch_vccnz L_RCY_S
L_RCY_R:
    v_rsq_f32 v136, v75
    v_mfma_f32_16x16x32_bf16 v[58:61], v[50:53], a[128:131], 0
    v_mfma_f32_16x16x32_bf16 v[62:65], v[50:53], a[132:135], 0
    s_waitcnt lgkmcnt(8)
    v_mfma_f32_32x32x16_bf16 v[224:239], a[136:139], a[4:7], v[224:239]
    ds_read_b64_tr_b16 a[128:129], v30 offset:8192
    ds_read_b64_tr_b16 a[130:131], v30 offset:8704
    v_add_f32 v142, 1.0, v76
    v_and_b32 v137, 0xffff0000, v74
    v_sub_f32 v137, v74, v137
    v_mfma_f32_32x32x16_bf16 v[240:255], a[140:143], a[4:7], v[240:255]
    ds_read_b64_tr_b16 a[132:133], v34 offset:8192
    ds_read_b64_tr_b16 a[134:135], v34 offset:8704
    v_rcp_f32 v90, v142
    s_waitcnt lgkmcnt(8)
    v_mfma_f32_32x32x16_bf16 v[224:239], a[144:147], a[8:11], v[224:239]
    ds_read_b64_tr_b16 a[136:137], v31 offset:8192
    ds_read_b64_tr_b16 a[138:139], v31 offset:8704
    v_mul_f32 v141, v75, v136
    v_mul_f32 v86, v141, v142
    v_mul_f32 v82, 0xc0135761, v136
    v_mfma_f32_32x32x16_bf16 v[240:255], a[148:151], a[8:11], v[240:255]
    ds_read_b64_tr_b16 a[140:141], v35 offset:8192
    ds_read_b64_tr_b16 a[142:143], v35 offset:8704
    v_mul_f32 v90, v90, v76
    v_mul_f32 v84, v136, v136
    s_waitcnt lgkmcnt(8)
    v_mfma_f32_32x32x16_bf16 v[224:239], a[152:155], a[12:15], v[224:239]
    ds_read_b64_tr_b16 a[144:145], v32 offset:8192
    ds_read_b64_tr_b16 a[146:147], v32 offset:8704
    v_mul_f32 v84, v84, v136
    v_mul_f32 v84, 0xbdd2d3e8, v84
    v_and_b32 v138, 0xffff0000, v137
    v_mfma_f32_32x32x16_bf16 v[240:255], a[156:159], a[12:15], v[240:255]
    ds_read_b64_tr_b16 a[148:149], v36 offset:8192
    ds_read_b64_tr_b16 a[150:151], v36 offset:8704
    v_sub_f32 v138, v137, v138
    v_and_b32 v139, 0xffff0000, v141
    s_waitcnt lgkmcnt(8)
    v_mfma_f32_32x32x16_bf16 v[224:239], a[128:131], a[16:19], v[224:239]
    ds_read_b64_tr_b16 a[152:153], v33 offset:8192
    ds_read_b64_tr_b16 a[154:155], v33 offset:8704
    v_sub_f32 v139, v141, v139
    v_and_b32 v140, 0xffff0000, v139
    v_sub_f32 v140, v139, v140
    v_mfma_f32_32x32x16_bf16 v[240:255], a[132:135], a[16:19], v[240:255]
    ds_read_b64_tr_b16 a[156:157], v37 offset:8192
    ds_read_b64_tr_b16 a[158:159], v37 offset:8704
    v_perm_b32 v78, v137, v74, s72
    v_perm_b32 v79, v74, v138, s72
    v_mfma_f32_16x16x32_bf16 v[58:61], v[50:53], a[128:131], v[58:61]
    v_mfma_f32_16x16x32_bf16 v[62:65], v[50:53], a[132:135], v[62:65]
    s_waitcnt lgkmcnt(8)
    v_mfma_f32_32x32x16_bf16 v[224:239], a[136:139], a[20:23], v[224:239]
    ds_read_b64_tr_b16 a[128:129], v30 offset:16384
    ds_read_b64_tr_b16 a[130:131], v30 offset:16896
    v_perm_b32 v80, v74, v137, s72
    v_perm_b32 v81, v139, v141, s72
    s_mov_b32 exec_lo, 0
    v_lshrrev_b32 v81, 16, v140
    v_mov_b32 v78, 0
    v_mov_b32 v79, 0
    v_mov_b32 v80, 0
    s_mov_b32 exec_lo, -1
    v_mfma_f32_32x32x16_bf16 v[240:255], a[140:143], a[20:23], v[240:255]
    ds_read_b64_tr_b16 a[132:133], v34 offset:16384
    ds_read_b64_tr_b16 a[134:135], v34 offset:16896
    s_waitcnt lgkmcnt(8)
    v_mfma_f32_32x32x16_bf16 v[224:239], a[144:147], a[24:27], v[224:239]
    ds_read_b64_tr_b16 a[136:137], v31 offset:16384
    ds_read_b64_tr_b16 a[138:139], v31 offset:16896
    v_mfma_f32_32x32x16_bf16 v[240:255], a[148:151], a[24:27], v[240:255]
    ds_read_b64_tr_b16 a[140:141], v35 offset:16384
    ds_read_b64_tr_b16 a[142:143], v35 offset:16896
    s_waitcnt lgkmcnt(8)
    v_mfma_f32_32x32x16_bf16 v[224:239], a[152:155], a[28:31], v[224:239]
    ds_read_b64_tr_b16 a[144:145], v32 offset:16384
    ds_read_b64_tr_b16 a[146:147], v32 offset:16896
    v_mfma_f32_32x32x16_bf16 v[240:255], a[156:159], a[28:31], v[240:255]
    ds_read_b64_tr_b16 a[148:149], v36 offset:16384
    ds_read_b64_tr_b16 a[150:151], v36 offset:16896
    s_waitcnt lgkmcnt(8)
    v_mfma_f32_32x32x16_bf16 v[224:239], a[128:131], a[32:35], v[224:239]
    ds_read_b64_tr_b16 a[152:153], v33 offset:16384
    ds_read_b64_tr_b16 a[154:155], v33 offset:16896
    v_mfma_f32_32x32x16_bf16 v[240:255], a[132:135], a[32:35], v[240:255]
    ds_read_b64_tr_b16 a[156:157], v37 offset:16384
    ds_read_b64_tr_b16 a[158:159], v37 offset:16896
    v_mfma_f32_16x16x32_bf16 v[58:61], v[50:53], a[128:131], v[58:61]
    v_mfma_f32_16x16x32_bf16 v[62:65], v[50:53], a[132:135], v[62:65]
    s_waitcnt lgkmcnt(8)
    v_mfma_f32_32x32x16_bf16 v[224:239], a[136:139], a[36:39], v[224:239]
    ds_read_b64_tr_b16 a[128:129], v30 offset:24576
    ds_read_b64_tr_b16 a[130:131], v30 offset:25088
    v_mfma_f32_32x32x16_bf16 v[240:255], a[140:143], a[36:39], v[240:255]
    ds_read_b64_tr_b16 a[132:133], v34 offset:24576
    ds_read_b64_tr_b16 a[134:135], v34 offset:25088
    s_waitcnt lgkmcnt(8)
    v_mfma_f32_32x32x16_bf16 v[224:239], a[144:147], a[40:43], v[224:239]
    ds_read_b64_tr_b16 a[136:137], v31 offset:24576
    ds_read_b64_tr_b16 a[138:139], v31 offset:25088
    v_mfma_f32_32x32x16_bf16 v[240:255], a[148:151], a[40:43], v[240:255]
    ds_read_b64_tr_b16 a[140:141], v35 offset:24576
    ds_read_b64_tr_b16 a[142:143], v35 offset:25088
    s_waitcnt lgkmcnt(8)
    v_mfma_f32_32x32x16_bf16 v[224:239], a[152:155], a[44:47], v[224:239]
    ds_read_b64_tr_b16 a[144:145], v32 offset:24576
    ds_read_b64_tr_b16 a[146:147], v32 offset:25088
    v_mfma_f32_32x32x16_bf16 v[240:255], a[156:159], a[44:47], v[240:255]
    ds_read_b64_tr_b16 a[148:149], v36 offset:24576
    ds_read_b64_tr_b16 a[150:151], v36 offset:25088
    s_waitcnt lgkmcnt(8)
    v_mfma_f32_32x32x16_bf16 v[224:239], a[128:131], a[48:51], v[224:239]
    ds_read_b64_tr_b16 a[152:153], v33 offset:24576
    ds_read_b64_tr_b16 a[154:155], v33 offset:25088
    v_mfma_f32_32x32x16_bf16 v[240:255], a[132:135], a[48:51], v[240:255]
    ds_read_b64_tr_b16 a[156:157], v37 offset:24576
    ds_read_b64_tr_b16 a[158:159], v37 offset:25088
    v_mfma_f32_16x16x32_bf16 v[58:61], v[50:53], a[128:131], v[58:61]
    v_mfma_f32_16x16x32_bf16 v[62:65], v[50:53], a[132:135], v[62:65]
    s_waitcnt lgkmcnt(8)
    v_mfma_f32_32x32x16_bf16 v[224:239], a[136:139], a[52:55], v[224:239]
    s_waitcnt vmcnt(3)
    s_waitcnt lgkmcnt(0)
    s_barrier
    ds_read_b64_tr_b16 a[160:161], v30 offset:32768
    ds_read_b64_tr_b16 a[162:163], v30 offset:33280
    ds_read_b64_tr_b16 a[168:169], v30 offset:40960
    ds_read_b64_tr_b16 a[170:171], v30 offset:41472
    v_mfma_f32_32x32x16_bf16 v[240:255], a[140:143], a[52:55], v[240:255]
    ds_read_b64_tr_b16 a[164:165], v34 offset:32768
    ds_read_b64_tr_b16 a[166:167], v34 offset:33280
    ds_read_b64_tr_b16 a[172:173], v34 offset:40960
    ds_read_b64_tr_b16 a[174:175], v34 offset:41472
    v_mfma_f32_32x32x16_bf16 v[224:239], a[144:147], a[56:59], v[224:239]
    ds_read_b64_tr_b16 a[136:137], v31 offset:32768
    ds_read_b64_tr_b16 a[138:139], v31 offset:33280
    ds_read_b64_tr_b16 a[176:177], v30 offset:49152
    ds_read_b64_tr_b16 a[178:179], v30 offset:49664
    v_mfma_f32_32x32x16_bf16 v[240:255], a[148:151], a[56:59], v[240:255]
    ds_read_b64_tr_b16 a[140:141], v35 offset:32768
    ds_read_b64_tr_b16 a[142:143], v35 offset:33280
    ds_read_b64_tr_b16 a[180:181], v34 offset:49152
    ds_read_b64_tr_b16 a[182:183], v34 offset:49664
    s_load_dwordx8 s[8:15], s[24:25], 0 glc
    v_mfma_f32_32x32x16_bf16 v[224:239], a[152:155], a[60:63], v[224:239]
    ds_read_b64_tr_b16 a[144:145], v32 offset:32768
    ds_read_b64_tr_b16 a[146:147], v32 offset:33280
    ds_read_b64_tr_b16 a[184:185], v30 offset:57344
    ds_read_b64_tr_b16 a[186:187], v30 offset:57856
    v_mfma_f32_32x32x16_bf16 v[240:255], a[156:159], a[60:63], v[240:255]
    ds_read_b64_tr_b16 a[148:149], v36 offset:32768
    ds_read_b64_tr_b16 a[150:151], v36 offset:33280
    ds_read_b64_tr_b16 a[188:189], v34 offset:57344
    ds_read_b64_tr_b16 a[190:191], v34 offset:57856
    s_waitcnt lgkmcnt(15)
    v_mfma_f32_16x16x32_bf16 v[58:61], v[50:53], a[160:163], v[58:61]
    s_waitcnt lgkmcnt(15)
    v_mfma_f32_16x16x32_bf16 v[62:65], v[50:53], a[164:167], v[62:65]
    v_mfma_f32_32x32x16_bf16 v[224:239], a[160:163], a[64:67], v[224:239]
    ds_read_b64_tr_b16 a[152:153], v33 offset:32768
    ds_read_b64_tr_b16 a[154:155], v33 offset:33280
    v_mfma_f32_32x32x16_bf16 v[240:255], a[164:167], a[64:67], v[240:255]
    ds_read_b64_tr_b16 a[156:157], v37 offset:32768
    ds_read_b64_tr_b16 a[158:159], v37 offset:33280
    v_mfma_f32_16x16x32_bf16 v[58:61], v[50:53], a[168:171], v[58:61]
    s_waitcnt lgkmcnt(15)
    v_mfma_f32_16x16x32_bf16 v[62:65], v[50:53], a[172:175], v[62:65]
    s_waitcnt lgkmcnt(14)
    v_mfma_f32_32x32x16_bf16 v[224:239], a[136:139], a[68:71], v[224:239]
    s_bfe_u32 s82, s61, 262144
    s_lshl_b32 s82, s82, 15
    s_add_u32 m0, s60, 65536
    s_add_u32 s82, s82, s3
    buffer_load_dwordx4 v18, s[32:35], s82 offen lds
    v_mfma_f32_32x32x16_bf16 v[240:255], a[140:143], a[68:71], v[240:255]
    v_mfma_f32_16x16x32_bf16 v[58:61], v[50:53], a[176:179], v[58:61]
    s_waitcnt lgkmcnt(12)
    v_mfma_f32_16x16x32_bf16 v[62:65], v[50:53], a[180:183], v[62:65]
    s_waitcnt lgkmcnt(6)
    v_mfma_f32_32x32x16_bf16 v[224:239], a[144:147], a[72:75], v[224:239]
    ds_read_b64_tr_b16 a[136:137], v31 offset:40960
    ds_read_b64_tr_b16 a[138:139], v31 offset:41472
    buffer_load_dwordx4 v19, s[32:35], s82 offen offset:1024 lds
    v_mfma_f32_32x32x16_bf16 v[240:255], a[148:151], a[72:75], v[240:255]
    ds_read_b64_tr_b16 a[140:141], v35 offset:40960
    ds_read_b64_tr_b16 a[142:143], v35 offset:41472
    v_mfma_f32_16x16x32_bf16 v[58:61], v[50:53], a[184:187], v[58:61]
    s_waitcnt lgkmcnt(8)
    v_mfma_f32_16x16x32_bf16 v[62:65], v[50:53], a[188:191], v[62:65]
    s_waitcnt lgkmcnt(4)
    v_mfma_f32_32x32x16_bf16 v[224:239], a[152:155], a[76:79], v[224:239]
    ds_read_b64_tr_b16 a[144:145], v32 offset:40960
    ds_read_b64_tr_b16 a[146:147], v32 offset:41472
    buffer_load_dwordx4 v20, s[32:35], s82 offen offset:2048 lds
    v_mfma_f32_32x32x16_bf16 v[240:255], a[156:159], a[76:79], v[240:255]
    ds_read_b64_tr_b16 a[148:149], v36 offset:40960
    ds_read_b64_tr_b16 a[150:151], v36 offset:41472
    ds_write_b32 v88, v66 offset:1024
    ds_write_b32 v88, v70 offset:1536
    ds_write_b32 v88, v58 offset:0
    ds_write_b32 v88, v62 offset:512
    v_mfma_f32_32x32x16_bf16 v[224:239], a[168:171], a[80:83], v[224:239]
    s_waitcnt lgkmcnt(0)
    s_cmp_lt_u32 s53, 2
    s_cselect_b64 s[12:13], s[28:29], s[12:13]
    s_cmp_lt_u32 s53, 1
    s_cselect_b64 s[10:11], s[28:29], s[10:11]
    s_cmp_eq_u64 s[8:9], s[28:29]
    s_cbranch_scc0 L_P1Y_S
    s_cmp_eq_u64 s[10:11], s[28:29]
    s_cbranch_scc0 L_P1Y_S
    s_cmp_eq_u64 s[12:13], s[28:29]
    s_cbranch_scc0 L_P1Y_S
L_P1Y_R:
    ds_write_b32 v98, v99 offset:3072
    buffer_load_dwordx4 v21, s[32:35], s82 offen offset:3072 lds
    s_waitcnt lgkmcnt(0)
    s_barrier
    ds_read_b128 v[144:147], v89 offset:1024
    ds_read_b128 v[148:151], v89 offset:1536
    ds_read_b128 v[152:155], v89 offset:0
    ds_read_b128 v[156:159], v89 offset:512
    ds_read_b64_tr_b16 a[152:153], v33 offset:40960
    ds_read_b64_tr_b16 a[154:155], v33 offset:41472
    s_add_u32 m0, s83, 33024
    s_nop 0
    buffer_load_dwordx4 v1, s[20:23], s93 offen offset:0 sc1 lds
    v_mfma_f32_32x32x16_bf16 v[240:255], a[172:175], a[80:83], v[240:255]
    ds_read_b64_tr_b16 a[156:157], v37 offset:40960
    ds_read_b64_tr_b16 a[158:159], v37 offset:41472
    s_waitcnt lgkmcnt(7)
    v_add_f32 v144, v144, v145
    v_add_f32 v146, v146, v147
    v_mfma_f32_32x32x16_bf16 v[224:239], a[136:139], a[84:87], v[224:239]
    buffer_load_dwordx4 v1, s[20:23], s93 offen offset:1024 sc1 lds
    v_lshl_or_b32 v69, v56, 16, v56
    v_add_f32 v144, v144, v146
    v_and_b32 v145, 0xffff0000, v144
    v_perm_b32 v66, v144, v144, s72
    v_mfma_f32_32x32x16_bf16 v[240:255], a[140:143], a[84:87], v[240:255]
    v_sub_f32 v145, v144, v145
    v_and_b32 v146, 0xffff0000, v145
    v_perm_b32 v67, v145, v144, s72
    v_sub_f32 v146, v145, v146
    v_mfma_f32_32x32x16_bf16 v[224:239], a[144:147], a[88:91], v[224:239]
    ds_read_b64_tr_b16 a[136:137], v31 offset:49152
    ds_read_b64_tr_b16 a[138:139], v31 offset:49664
    buffer_load_dwordx4 v1, s[20:23], s93 offen offset:2048 sc1 lds
    v_perm_b32 v68, v146, v145, s72
    s_waitcnt lgkmcnt(8)
    v_add_f32 v148, v148, v149
    v_mfma_f32_32x32x16_bf16 v[240:255], a[148:151], a[88:91], v[240:255]
    ds_read_b64_tr_b16 a[140:141], v35 offset:49152
    ds_read_b64_tr_b16 a[142:143], v35 offset:49664
    v_add_f32 v150, v150, v151
    v_lshl_or_b32 v73, v57, 16, v57
    s_waitcnt lgkmcnt(4)
    v_mfma_f32_32x32x16_bf16 v[224:239], a[152:155], a[92:95], v[224:239]
    ds_read_b64_tr_b16 a[144:145], v32 offset:49152
    ds_read_b64_tr_b16 a[146:147], v32 offset:49664
    s_add_u32 m0, s83, 33040
    s_nop 0
    buffer_load_dwordx4 v1, s[20:23], s93 offen offset:3072 sc1 lds
    v_mfma_f32_32x32x16_bf16 v[240:255], a[156:159], a[92:95], v[240:255]
    ds_read_b64_tr_b16 a[148:149], v36 offset:49152
    ds_read_b64_tr_b16 a[150:151], v36 offset:49664
    v_add_f32 v148, v148, v150
    v_and_b32 v149, 0xffff0000, v148
    v_mfma_f32_32x32x16_bf16 v[224:239], a[176:179], a[96:99], v[224:239]
    ds_read_b64_tr_b16 a[152:153], v33 offset:49152
    ds_read_b64_tr_b16 a[154:155], v33 offset:49664
    s_add_u32 m0, s83, 16512
    s_nop 0
    buffer_load_dwordx4 v91, s[20:23], s92 offen offset:0 sc1 lds
    v_mfma_f32_32x32x16_bf16 v[240:255], a[180:183], a[96:99], v[240:255]
    ds_read_b64_tr_b16 a[156:157], v37 offset:49152
    ds_read_b64_tr_b16 a[158:159], v37 offset:49664
    v_perm_b32 v70, v148, v148, s72
    v_sub_f32 v149, v148, v149
    s_waitcnt lgkmcnt(8)
    v_mfma_f32_32x32x16_bf16 v[224:239], a[136:139], a[100:103], v[224:239]
    buffer_load_dwordx4 v91, s[20:23], s92 offen offset:1024 sc1 lds
    v_and_b32 v150, 0xffff0000, v149
    v_perm_b32 v71, v149, v148, s72
    v_sub_f32 v150, v149, v150
    v_perm_b32 v72, v150, v149, s72
    v_mfma_f32_32x32x16_bf16 v[240:255], a[140:143], a[100:103], v[240:255]
    v_add_f32 v152, v152, v153
    v_add_f32 v154, v154, v155
    v_lshl_or_b32 v61, v54, 16, v54
    v_add_f32 v152, v152, v154
    s_waitcnt lgkmcnt(4)
    v_mfma_f32_32x32x16_bf16 v[224:239], a[144:147], a[104:107], v[224:239]
    ds_read_b64_tr_b16 a[136:137], v31 offset:57344
    ds_read_b64_tr_b16 a[138:139], v31 offset:57856
    buffer_load_dwordx4 v91, s[20:23], s92 offen offset:2048 sc1 lds
    v_and_b32 v153, 0xffff0000, v152
    v_perm_b32 v58, v152, v152, s72
    v_mfma_f32_32x32x16_bf16 v[240:255], a[148:151], a[104:107], v[240:255]
    ds_read_b64_tr_b16 a[140:141], v35 offset:57344
    ds_read_b64_tr_b16 a[142:143], v35 offset:57856
    v_sub_f32 v153, v152, v153
    v_and_b32 v154, 0xffff0000, v153
    s_waitcnt lgkmcnt(4)
    v_mfma_f32_32x32x16_bf16 v[224:239], a[152:155], a[108:111], v[224:239]
    ds_read_b64_tr_b16 a[144:145], v32 offset:57344
    ds_read_b64_tr_b16 a[146:147], v32 offset:57856
    s_add_u32 m0, s83, 16528
    s_nop 0
    buffer_load_dwordx4 v91, s[20:23], s92 offen offset:3072 sc1 lds
    v_mfma_f32_32x32x16_bf16 v[240:255], a[156:159], a[108:111], v[240:255]
    ds_read_b64_tr_b16 a[148:149], v36 offset:57344
    ds_read_b64_tr_b16 a[150:151], v36 offset:57856
    v_perm_b32 v59, v153, v152, s72
    v_sub_f32 v154, v153, v154
    v_mfma_f32_32x32x16_bf16 v[224:239], a[184:187], a[112:115], v[224:239]
    ds_read_b64_tr_b16 a[152:153], v33 offset:57344
    ds_read_b64_tr_b16 a[154:155], v33 offset:57856
    s_add_u32 m0, s83, 0
    s_nop 0
    buffer_load_dwordx4 v92, s[20:23], s91 offen offset:0 sc1 lds
    v_mfma_f32_32x32x16_bf16 v[240:255], a[188:191], a[112:115], v[240:255]
    ds_read_b64_tr_b16 a[156:157], v37 offset:57344
    ds_read_b64_tr_b16 a[158:159], v37 offset:57856
    v_perm_b32 v60, v154, v153, s72
    v_add_f32 v156, v156, v157
    s_waitcnt lgkmcnt(8)
    v_mfma_f32_32x32x16_bf16 v[224:239], a[136:139], a[116:119], v[224:239]
    buffer_load_dwordx4 v92, s[20:23], s91 offen offset:1024 sc1 lds
    v_add_f32 v158, v158, v159
    v_lshl_or_b32 v65, v55, 16, v55
    v_add_f32 v156, v156, v158
    v_and_b32 v157, 0xffff0000, v156
    v_mfma_f32_32x32x16_bf16 v[240:255], a[140:143], a[116:119], v[240:255]
    v_perm_b32 v62, v156, v156, s72
    v_sub_f32 v157, v156, v157
    v_and_b32 v158, 0xffff0000, v157
    v_perm_b32 v63, v157, v156, s72
    s_waitcnt lgkmcnt(4)
    v_mfma_f32_32x32x16_bf16 v[224:239], a[144:147], a[120:123], v[224:239]
    buffer_load_dwordx4 v92, s[20:23], s91 offen offset:2048 sc1 lds
    v_sub_f32 v158, v157, v158
    v_perm_b32 v64, v158, v157, s72
    v_mfma_f32_32x32x16_bf16 v[240:255], a[148:151], a[120:123], v[240:255]
    s_waitcnt lgkmcnt(0)
    v_mfma_f32_32x32x16_bf16 v[224:239], a[152:155], a[124:127], v[224:239]
    s_add_u32 m0, s83, 16
    s_nop 0
    buffer_load_dwordx4 v92, s[20:23], s91 offen offset:3072 sc1 lds
    v_mfma_f32_32x32x16_bf16 v[240:255], a[156:159], a[124:127], v[240:255]
    s_load_dwordx8 s[8:15], s[24:25], 0 glc
    v_mfma_f32_32x32x16_bf16 v[192:207], v[66:69], v[78:81], v[192:207]
    s_bfe_u32 s82, s61, 262148
    s_lshl_b32 s82, s82, 15
    s_add_u32 m0, s60, 81920
    s_add_u32 s82, s82, s3
    buffer_load_dwordx4 v18, s[32:35], s82 offen lds
    v_mfma_f32_32x32x16_bf16 v[208:223], v[70:73], v[78:81], v[208:223]
    v_mfma_f32_32x32x16_bf16 v[224:239], v[58:61], v[78:81], v[224:239]
    buffer_load_dwordx4 v19, s[32:35], s82 offen offset:1024 lds
    v_mfma_f32_32x32x16_bf16 v[240:255], v[62:65], v[78:81], v[240:255]
    s_barrier
    s_nop 1
    v_pk_mul_f32 v[136:137], v[192:193], v[192:193]
    v_pk_mul_f32 v[138:139], v[194:195], v[194:195]
    v_pk_mul_f32 v[140:141], v[196:197], v[196:197]
    v_pk_mul_f32 v[142:143], v[198:199], v[198:199]
    v_pk_mul_f32 v[144:145], v[200:201], v[200:201]
    v_pk_mul_f32 v[146:147], v[202:203], v[202:203]
    v_pk_mul_f32 v[148:149], v[204:205], v[204:205]
    v_pk_mul_f32 v[150:151], v[206:207], v[206:207]
    v_pk_fma_f32 v[136:137], v[136:137], v[84:85], v[82:83] op_sel_hi:[1,0,0]
    v_pk_fma_f32 v[138:139], v[138:139], v[84:85], v[82:83] op_sel_hi:[1,0,0]
    v_pk_fma_f32 v[140:141], v[140:141], v[84:85], v[82:83] op_sel_hi:[1,0,0]
    v_pk_fma_f32 v[142:143], v[142:143], v[84:85], v[82:83] op_sel_hi:[1,0,0]
    v_pk_fma_f32 v[144:145], v[144:145], v[84:85], v[82:83] op_sel_hi:[1,0,0]
    v_pk_fma_f32 v[146:147], v[146:147], v[84:85], v[82:83] op_sel_hi:[1,0,0]
    v_pk_fma_f32 v[148:149], v[148:149], v[84:85], v[82:83] op_sel_hi:[1,0,0]
    v_pk_fma_f32 v[150:151], v[150:151], v[84:85], v[82:83] op_sel_hi:[1,0,0]
    buffer_load_dwordx4 v20, s[32:35], s82 offen offset:2048 lds
    v_pk_mul_f32 v[136:137], v[136:137], v[192:193]
    v_pk_mul_f32 v[138:139], v[138:139], v[194:195]
    v_pk_mul_f32 v[140:141], v[140:141], v[196:197]
    v_pk_mul_f32 v[142:143], v[142:143], v[198:199]
    v_pk_mul_f32 v[144:145], v[144:145], v[200:201]
    v_pk_mul_f32 v[146:147], v[146:147], v[202:203]
    v_pk_mul_f32 v[148:149], v[148:149], v[204:205]
    v_pk_mul_f32 v[150:151], v[150:151], v[206:207]
    v_exp_f32 v136, v136
    v_exp_f32 v137, v137
    v_exp_f32 v138, v138
    v_exp_f32 v139, v139
    buffer_load_dwordx4 v21, s[32:35], s82 offen offset:3072 lds
    v_exp_f32 v140, v140
    v_exp_f32 v141, v141
    v_exp_f32 v142, v142
    v_exp_f32 v143, v143
    v_exp_f32 v144, v144
    v_exp_f32 v145, v145
    v_exp_f32 v146, v146
    v_exp_f32 v147, v147
    s_bfe_u32 s82, s61, 262152
    s_lshl_b32 s82, s82, 15
    s_add_u32 m0, s60, 98304
    s_add_u32 s82, s82, s3
    buffer_load_dwordx4 v18, s[32:35], s82 offen lds
    v_exp_f32 v148, v148
    v_exp_f32 v149, v149
    v_exp_f32 v150, v150
    v_exp_f32 v151, v151
    v_pk_fma_f32 v[136:137], v[136:137], v[86:87], v[86:87] op_sel_hi:[1,0,0]
    v_pk_fma_f32 v[138:139], v[138:139], v[86:87], v[86:87] op_sel_hi:[1,0,0]
    v_pk_fma_f32 v[140:141], v[140:141], v[86:87], v[86:87] op_sel_hi:[1,0,0]
    v_pk_fma_f32 v[142:143], v[142:143], v[86:87], v[86:87] op_sel_hi:[1,0,0]
    v_pk_fma_f32 v[144:145], v[144:145], v[86:87], v[86:87] op_sel_hi:[1,0,0]
    v_pk_fma_f32 v[146:147], v[146:147], v[86:87], v[86:87] op_sel_hi:[1,0,0]
    v_pk_fma_f32 v[148:149], v[148:149], v[86:87], v[86:87] op_sel_hi:[1,0,0]
    v_pk_fma_f32 v[150:151], v[150:151], v[86:87], v[86:87] op_sel_hi:[1,0,0]
    buffer_load_dwordx4 v19, s[32:35], s82 offen offset:1024 lds
    v_rcp_f32 v136, v136
    v_rcp_f32 v137, v137
    v_rcp_f32 v138, v138
    v_rcp_f32 v139, v139
    v_rcp_f32 v140, v140
    v_rcp_f32 v141, v141
    v_rcp_f32 v142, v142
    v_rcp_f32 v143, v143
    s_waitcnt lgkmcnt(0)
    s_cmp_eq_u64 s[14:15], s[28:29]
    s_cbranch_scc0 L_PQ_S
L_PQ_R:
    buffer_load_dwordx4 v[2:5], v1, s[20:23], s77 offen offset:0 sc1
    buffer_load_dwordx4 v[6:9], v1, s[20:23], s77 offen offset:1024 sc1
    buffer_load_dwordx4 v20, s[32:35], s82 offen offset:2048 lds
    s_waitcnt vmcnt(21)
    ds_read_b64_tr_b16 a[160:161], v102 offset:0
    ds_read_b64_tr_b16 a[162:163], v102 offset:1024
    v_rcp_f32 v144, v144
    v_rcp_f32 v145, v145
    v_rcp_f32 v146, v146
    v_rcp_f32 v147, v147
    v_rcp_f32 v148, v148
    v_rcp_f32 v149, v149
    v_rcp_f32 v150, v150
    v_rcp_f32 v151, v151
    buffer_load_dwordx4 v21, s[32:35], s82 offen offset:3072 lds
    ds_read_b64_tr_b16 a[164:165], v103 offset:0
    ds_read_b64_tr_b16 a[166:167], v103 offset:1024
    v_pk_mul_f32 v[136:137], v[136:137], v[192:193]
    v_pk_mul_f32 v[138:139], v[138:139], v[194:195]
    v_pk_mul_f32 v[140:141], v[140:141], v[196:197]
    v_pk_mul_f32 v[142:143], v[142:143], v[198:199]
    v_pk_mul_f32 v[144:145], v[144:145], v[200:201]
    v_pk_mul_f32 v[146:147], v[146:147], v[202:203]
    v_pk_mul_f32 v[148:149], v[148:149], v[204:205]
    v_pk_mul_f32 v[150:151], v[150:151], v[206:207]
    v_cvt_pk_bf16_f32 v192, v136, v137
    v_cvt_pk_bf16_f32 v193, v138, v139
    v_cvt_pk_bf16_f32 v194, v140, v141
    v_cvt_pk_bf16_f32 v195, v142, v143
    v_cvt_pk_bf16_f32 v196, v144, v145
    v_cvt_pk_bf16_f32 v197, v146, v147
    v_cvt_pk_bf16_f32 v198, v148, v149
    v_cvt_pk_bf16_f32 v199, v150, v151
    s_add_u32 s94, s67, 0
    s_lshl_b32 s94, s94, 11
    s_add_u32 s94, s94, s71
    buffer_store_dwordx4 v[192:195], v1, s[20:23], s94 offen sc1
    ds_read_b64_tr_b16 a[168:169], v102 offset:2048
    ds_read_b64_tr_b16 a[170:171], v102 offset:3072
    ds_read_b64_tr_b16 a[172:173], v103 offset:2048
    ds_read_b64_tr_b16 a[174:175], v103 offset:3072
    v_pk_mul_f32 v[136:137], v[208:209], v[208:209]
    v_pk_mul_f32 v[138:139], v[210:211], v[210:211]
    v_pk_mul_f32 v[140:141], v[212:213], v[212:213]
    v_pk_mul_f32 v[142:143], v[214:215], v[214:215]
    v_pk_mul_f32 v[144:145], v[216:217], v[216:217]
    v_pk_mul_f32 v[146:147], v[218:219], v[218:219]
    v_pk_mul_f32 v[148:149], v[220:221], v[220:221]
    v_pk_mul_f32 v[150:151], v[222:223], v[222:223]
    v_pk_fma_f32 v[136:137], v[136:137], v[84:85], v[82:83] op_sel_hi:[1,0,0]
    v_pk_fma_f32 v[138:139], v[138:139], v[84:85], v[82:83] op_sel_hi:[1,0,0]
    v_pk_fma_f32 v[140:141], v[140:141], v[84:85], v[82:83] op_sel_hi:[1,0,0]
    v_pk_fma_f32 v[142:143], v[142:143], v[84:85], v[82:83] op_sel_hi:[1,0,0]
    v_pk_fma_f32 v[144:145], v[144:145], v[84:85], v[82:83] op_sel_hi:[1,0,0]
    v_pk_fma_f32 v[146:147], v[146:147], v[84:85], v[82:83] op_sel_hi:[1,0,0]
    v_pk_fma_f32 v[148:149], v[148:149], v[84:85], v[82:83] op_sel_hi:[1,0,0]
    v_pk_fma_f32 v[150:151], v[150:151], v[84:85], v[82:83] op_sel_hi:[1,0,0]
    buffer_store_dwordx4 v[196:199], v1, s[20:23], s94 offen offset:1024 sc1
    v_pk_mul_f32 v[136:137], v[136:137], v[208:209]
    v_pk_mul_f32 v[138:139], v[138:139], v[210:211]
    v_pk_mul_f32 v[140:141], v[140:141], v[212:213]
    v_pk_mul_f32 v[142:143], v[142:143], v[214:215]
    v_pk_mul_f32 v[144:145], v[144:145], v[216:217]
    v_pk_mul_f32 v[146:147], v[146:147], v[218:219]
    v_pk_mul_f32 v[148:149], v[148:149], v[220:221]
    v_pk_mul_f32 v[150:151], v[150:151], v[222:223]
    v_exp_f32 v136, v136
    v_exp_f32 v137, v137
    v_exp_f32 v138, v138
    v_exp_f32 v139, v139
    s_bfe_u32 s82, s61, 262156
    s_lshl_b32 s82, s82, 15
    s_add_u32 m0, s60, 114688
    s_add_u32 s82, s82, s3
    buffer_load_dwordx4 v18, s[32:35], s82 offen lds
    v_exp_f32 v140, v140
    v_exp_f32 v141, v141
    v_exp_f32 v142, v142
    v_exp_f32 v143, v143
    v_exp_f32 v144, v144
    v_exp_f32 v145, v145
    v_exp_f32 v146, v146
    v_exp_f32 v147, v147
    buffer_load_dwordx4 v19, s[32:35], s82 offen offset:1024 lds
    s_waitcnt vmcnt(10)
    ds_read_b64_tr_b16 a[176:177], v102 offset:16384
    ds_read_b64_tr_b16 a[178:179], v102 offset:17408
    v_exp_f32 v148, v148
    v_exp_f32 v149, v149
    v_exp_f32 v150, v150
    v_exp_f32 v151, v151
    v_pk_fma_f32 v[136:137], v[136:137], v[86:87], v[86:87] op_sel_hi:[1,0,0]
    v_pk_fma_f32 v[138:139], v[138:139], v[86:87], v[86:87] op_sel_hi:[1,0,0]
    v_pk_fma_f32 v[140:141], v[140:141], v[86:87], v[86:87] op_sel_hi:[1,0,0]
    v_pk_fma_f32 v[142:143], v[142:143], v[86:87], v[86:87] op_sel_hi:[1,0,0]
    v_pk_fma_f32 v[144:145], v[144:145], v[86:87], v[86:87] op_sel_hi:[1,0,0]
    v_pk_fma_f32 v[146:147], v[146:147], v[86:87], v[86:87] op_sel_hi:[1,0,0]
    v_pk_fma_f32 v[148:149], v[148:149], v[86:87], v[86:87] op_sel_hi:[1,0,0]
    v_pk_fma_f32 v[150:151], v[150:151], v[86:87], v[86:87] op_sel_hi:[1,0,0]
    buffer_load_dwordx4 v20, s[32:35], s82 offen offset:2048 lds
    ds_read_b64_tr_b16 a[180:181], v103 offset:16384
    ds_read_b64_tr_b16 a[182:183], v103 offset:17408
    v_rcp_f32 v136, v136
    v_rcp_f32 v137, v137
    v_rcp_f32 v138, v138
    v_rcp_f32 v139, v139
    v_rcp_f32 v140, v140
    v_rcp_f32 v141, v141
    v_rcp_f32 v142, v142
    v_rcp_f32 v143, v143
    buffer_load_dwordx4 v21, s[32:35], s82 offen offset:3072 lds
    ds_read_b64_tr_b16 a[184:185], v102 offset:18432
    ds_read_b64_tr_b16 a[186:187], v102 offset:19456
    v_rcp_f32 v144, v144
    v_rcp_f32 v145, v145
    v_rcp_f32 v146, v146
    v_rcp_f32 v147, v147
    v_rcp_f32 v148, v148
    v_rcp_f32 v149, v149
    v_rcp_f32 v150, v150
    v_rcp_f32 v151, v151
    s_waitcnt lgkmcnt(6)
    s_bfe_u32 s82, s61, 262160
    s_lshl_b32 s82, s82, 15
    s_add_u32 m0, s60, 65536
    s_add_u32 s82, s82, s3
    buffer_load_dwordx4 v18, s[32:35], s82 offen lds
    v_pk_mul_f32 v[136:137], v[136:137], v[208:209]
    v_pk_mul_f32 v[138:139], v[138:139], v[210:211]
    v_pk_mul_f32 v[140:141], v[140:141], v[212:213]
    v_pk_mul_f32 v[142:143], v[142:143], v[214:215]
    v_pk_mul_f32 v[144:145], v[144:145], v[216:217]
    v_pk_mul_f32 v[146:147], v[146:147], v[218:219]
    v_pk_mul_f32 v[148:149], v[148:149], v[220:221]
    v_pk_mul_f32 v[150:151], v[150:151], v[222:223]
    v_cvt_pk_bf16_f32 v208, v136, v137
    v_cvt_pk_bf16_f32 v209, v138, v139
    v_cvt_pk_bf16_f32 v210, v140, v141
    v_cvt_pk_bf16_f32 v211, v142, v143
    v_cvt_pk_bf16_f32 v212, v144, v145
    v_cvt_pk_bf16_f32 v213, v146, v147
    v_cvt_pk_bf16_f32 v214, v148, v149
    v_cvt_pk_bf16_f32 v215, v150, v151
    s_add_u32 s95, s67, 1
    s_lshl_b32 s95, s95, 11
    s_add_u32 s95, s95, s71
    buffer_store_dwordx4 v[208:211], v1, s[20:23], s95 offen sc1
    ds_read_b64_tr_b16 a[188:189], v103 offset:18432
    ds_read_b64_tr_b16 a[190:191], v103 offset:19456
    s_waitcnt vmcnt(8)
    ds_read_b64_tr_b16 a[192:193], v102 offset:32768
    ds_read_b64_tr_b16 a[194:195], v102 offset:33792
    v_pk_mul_f32 v[136:137], v[224:225], v[224:225]
    v_pk_mul_f32 v[138:139], v[226:227], v[226:227]
    v_pk_mul_f32 v[140:141], v[228:229], v[228:229]
    v_pk_mul_f32 v[142:143], v[230:231], v[230:231]
    v_pk_mul_f32 v[144:145], v[232:233], v[232:233]
    v_pk_mul_f32 v[146:147], v[234:235], v[234:235]
    v_pk_mul_f32 v[148:149], v[236:237], v[236:237]
    v_pk_mul_f32 v[150:151], v[238:239], v[238:239]
    v_pk_fma_f32 v[136:137], v[136:137], v[84:85], v[82:83] op_sel_hi:[1,0,0]
    v_pk_fma_f32 v[138:139], v[138:139], v[84:85], v[82:83] op_sel_hi:[1,0,0]
    v_pk_fma_f32 v[140:141], v[140:141], v[84:85], v[82:83] op_sel_hi:[1,0,0]
    v_pk_fma_f32 v[142:143], v[142:143], v[84:85], v[82:83] op_sel_hi:[1,0,0]
    v_pk_fma_f32 v[144:145], v[144:145], v[84:85], v[82:83] op_sel_hi:[1,0,0]
    v_pk_fma_f32 v[146:147], v[146:147], v[84:85], v[82:83] op_sel_hi:[1,0,0]
    v_pk_fma_f32 v[148:149], v[148:149], v[84:85], v[82:83] op_sel_hi:[1,0,0]
    v_pk_fma_f32 v[150:151], v[150:151], v[84:85], v[82:83] op_sel_hi:[1,0,0]
    buffer_store_dwordx4 v[212:215], v1, s[20:23], s95 offen offset:1024 sc1
    ds_read_b64_tr_b16 a[196:197], v103 offset:32768
    ds_read_b64_tr_b16 a[198:199], v103 offset:33792
    v_pk_mul_f32 v[136:137], v[136:137], v[224:225]
    v_pk_mul_f32 v[138:139], v[138:139], v[226:227]
    v_pk_mul_f32 v[140:141], v[140:141], v[228:229]
    v_pk_mul_f32 v[142:143], v[142:143], v[230:231]
    v_pk_mul_f32 v[144:145], v[144:145], v[232:233]
    v_pk_mul_f32 v[146:147], v[146:147], v[234:235]
    v_pk_mul_f32 v[148:149], v[148:149], v[236:237]
    v_pk_mul_f32 v[150:151], v[150:151], v[238:239]
    v_exp_f32 v136, v136
    v_exp_f32 v137, v137
    v_exp_f32 v138, v138
    v_exp_f32 v139, v139
    buffer_load_dwordx4 v19, s[32:35], s82 offen offset:1024 lds
    ds_read_b64_tr_b16 a[200:201], v102 offset:34816
    ds_read_b64_tr_b16 a[202:203], v102 offset:35840
    v_exp_f32 v140, v140
    v_exp_f32 v141, v141
    v_exp_f32 v142, v142
    v_exp_f32 v143, v143
    v_exp_f32 v144, v144
    v_exp_f32 v145, v145
    v_exp_f32 v146, v146
    v_exp_f32 v147, v147
    buffer_load_dwordx4 v20, s[32:35], s82 offen offset:2048 lds
    ds_read_b64_tr_b16 a[204:205], v103 offset:34816
    ds_read_b64_tr_b16 a[206:207], v103 offset:35840
    v_exp_f32 v148, v148
    v_exp_f32 v149, v149
    v_exp_f32 v150, v150
    v_exp_f32 v151, v151
    v_pk_fma_f32 v[136:137], v[136:137], v[86:87], v[86:87] op_sel_hi:[1,0,0]
    v_pk_fma_f32 v[138:139], v[138:139], v[86:87], v[86:87] op_sel_hi:[1,0,0]
    v_pk_fma_f32 v[140:141], v[140:141], v[86:87], v[86:87] op_sel_hi:[1,0,0]
    v_pk_fma_f32 v[142:143], v[142:143], v[86:87], v[86:87] op_sel_hi:[1,0,0]
    v_pk_fma_f32 v[144:145], v[144:145], v[86:87], v[86:87] op_sel_hi:[1,0,0]
    v_pk_fma_f32 v[146:147], v[146:147], v[86:87], v[86:87] op_sel_hi:[1,0,0]
    v_pk_fma_f32 v[148:149], v[148:149], v[86:87], v[86:87] op_sel_hi:[1,0,0]
    v_pk_fma_f32 v[150:151], v[150:151], v[86:87], v[86:87] op_sel_hi:[1,0,0]
    buffer_load_dwordx4 v21, s[32:35], s82 offen offset:3072 lds
    v_rcp_f32 v136, v136
    v_rcp_f32 v137, v137
    v_rcp_f32 v138, v138
    v_rcp_f32 v139, v139
    v_rcp_f32 v140, v140
    v_rcp_f32 v141, v141
    v_rcp_f32 v142, v142
    v_rcp_f32 v143, v143
    s_waitcnt lgkmcnt(8)
    s_bfe_u32 s82, s61, 262164
    s_lshl_b32 s82, s82, 15
    s_add_u32 m0, s60, 81920
    s_add_u32 s82, s82, s3
    buffer_load_dwordx4 v18, s[32:35], s82 offen lds
    v_rcp_f32 v144, v144
    v_rcp_f32 v145, v145
    v_rcp_f32 v146, v146
    v_rcp_f32 v147, v147
    v_rcp_f32 v148, v148
    v_rcp_f32 v149, v149
    v_rcp_f32 v150, v150
    v_rcp_f32 v151, v151
    buffer_load_dwordx4 v19, s[32:35], s82 offen offset:1024 lds
    v_pk_mul_f32 v[136:137], v[136:137], v[224:225]
    v_pk_mul_f32 v[138:139], v[138:139], v[226:227]
    v_pk_mul_f32 v[140:141], v[140:141], v[228:229]
    v_pk_mul_f32 v[142:143], v[142:143], v[230:231]
    v_pk_mul_f32 v[144:145], v[144:145], v[232:233]
    v_pk_mul_f32 v[146:147], v[146:147], v[234:235]
    v_pk_mul_f32 v[148:149], v[148:149], v[236:237]
    v_pk_mul_f32 v[150:151], v[150:151], v[238:239]
    v_cvt_pk_bf16_f32 v224, v136, v137
    v_cvt_pk_bf16_f32 v225, v138, v139
    v_cvt_pk_bf16_f32 v226, v140, v141
    v_cvt_pk_bf16_f32 v227, v142, v143
    v_cvt_pk_bf16_f32 v228, v144, v145
    v_cvt_pk_bf16_f32 v229, v146, v147
    v_cvt_pk_bf16_f32 v230, v148, v149
    v_cvt_pk_bf16_f32 v231, v150, v151
    s_add_u32 s96, s68, 0
    s_lshl_b32 s96, s96, 11
    s_add_u32 s96, s96, s71
    buffer_store_dwordx4 v[224:227], v1, s[20:23], s96 offen sc1
    v_pk_mul_f32 v[136:137], v[240:241], v[240:241]
    v_pk_mul_f32 v[138:139], v[242:243], v[242:243]
    v_pk_mul_f32 v[140:141], v[244:245], v[244:245]
    v_pk_mul_f32 v[142:143], v[246:247], v[246:247]
    v_pk_mul_f32 v[144:145], v[248:249], v[248:249]
    v_pk_mul_f32 v[146:147], v[250:251], v[250:251]
    v_pk_mul_f32 v[148:149], v[252:253], v[252:253]
    v_pk_mul_f32 v[150:151], v[254:255], v[254:255]
    v_pk_fma_f32 v[136:137], v[136:137], v[84:85], v[82:83] op_sel_hi:[1,0,0]
    v_pk_fma_f32 v[138:139], v[138:139], v[84:85], v[82:83] op_sel_hi:[1,0,0]
    v_pk_fma_f32 v[140:141], v[140:141], v[84:85], v[82:83] op_sel_hi:[1,0,0]
    v_pk_fma_f32 v[142:143], v[142:143], v[84:85], v[82:83] op_sel_hi:[1,0,0]
    v_pk_fma_f32 v[144:145], v[144:145], v[84:85], v[82:83] op_sel_hi:[1,0,0]
    v_pk_fma_f32 v[146:147], v[146:147], v[84:85], v[82:83] op_sel_hi:[1,0,0]
    v_pk_fma_f32 v[148:149], v[148:149], v[84:85], v[82:83] op_sel_hi:[1,0,0]
    v_pk_fma_f32 v[150:151], v[150:151], v[84:85], v[82:83] op_sel_hi:[1,0,0]
    buffer_store_dwordx4 v[228:231], v1, s[20:23], s96 offen offset:1024 sc1
    v_pk_mul_f32 v[136:137], v[136:137], v[240:241]
    v_pk_mul_f32 v[138:139], v[138:139], v[242:243]
    v_pk_mul_f32 v[140:141], v[140:141], v[244:245]
    v_pk_mul_f32 v[142:143], v[142:143], v[246:247]
    v_pk_mul_f32 v[144:145], v[144:145], v[248:249]
    v_pk_mul_f32 v[146:147], v[146:147], v[250:251]
    v_pk_mul_f32 v[148:149], v[148:149], v[252:253]
    v_pk_mul_f32 v[150:151], v[150:151], v[254:255]
    v_exp_f32 v136, v136
    v_exp_f32 v137, v137
    v_exp_f32 v138, v138
    v_exp_f32 v139, v139
    buffer_load_dwordx4 v20, s[32:35], s82 offen offset:2048 lds
    v_exp_f32 v140, v140
    v_exp_f32 v141, v141
    v_exp_f32 v142, v142
    v_exp_f32 v143, v143
    v_exp_f32 v144, v144
    v_exp_f32 v145, v145
    v_exp_f32 v146, v146
    v_exp_f32 v147, v147
    buffer_load_dwordx4 v21, s[32:35], s82 offen offset:3072 lds
    v_exp_f32 v148, v148
    v_exp_f32 v149, v149
    v_exp_f32 v150, v150
    v_exp_f32 v151, v151
    v_pk_fma_f32 v[136:137], v[136:137], v[86:87], v[86:87] op_sel_hi:[1,0,0]
    v_pk_fma_f32 v[138:139], v[138:139], v[86:87], v[86:87] op_sel_hi:[1,0,0]
    v_pk_fma_f32 v[140:141], v[140:141], v[86:87], v[86:87] op_sel_hi:[1,0,0]
    v_pk_fma_f32 v[142:143], v[142:143], v[86:87], v[86:87] op_sel_hi:[1,0,0]
    v_pk_fma_f32 v[144:145], v[144:145], v[86:87], v[86:87] op_sel_hi:[1,0,0]
    v_pk_fma_f32 v[146:147], v[146:147], v[86:87], v[86:87] op_sel_hi:[1,0,0]
    v_pk_fma_f32 v[148:149], v[148:149], v[86:87], v[86:87] op_sel_hi:[1,0,0]
    v_pk_fma_f32 v[150:151], v[150:151], v[86:87], v[86:87] op_sel_hi:[1,0,0]
    v_rcp_f32 v136, v136
    v_rcp_f32 v137, v137
    v_rcp_f32 v138, v138
    v_rcp_f32 v139, v139
    v_rcp_f32 v140, v140
    v_rcp_f32 v141, v141
    v_rcp_f32 v142, v142
    v_rcp_f32 v143, v143
    v_rcp_f32 v144, v144
    v_rcp_f32 v145, v145
    v_rcp_f32 v146, v146
    v_rcp_f32 v147, v147
    v_rcp_f32 v148, v148
    v_rcp_f32 v149, v149
    v_rcp_f32 v150, v150
    v_rcp_f32 v151, v151
    v_pk_mul_f32 v[136:137], v[136:137], v[240:241]
    v_pk_mul_f32 v[138:139], v[138:139], v[242:243]
    v_pk_mul_f32 v[140:141], v[140:141], v[244:245]
    v_pk_mul_f32 v[142:143], v[142:143], v[246:247]
    v_pk_mul_f32 v[144:145], v[144:145], v[248:249]
    v_pk_mul_f32 v[146:147], v[146:147], v[250:251]
    v_pk_mul_f32 v[148:149], v[148:149], v[252:253]
    v_pk_mul_f32 v[150:151], v[150:151], v[254:255]
    v_cvt_pk_bf16_f32 v240, v136, v137
    v_cvt_pk_bf16_f32 v241, v138, v139
    v_cvt_pk_bf16_f32 v242, v140, v141
    v_cvt_pk_bf16_f32 v243, v142, v143
    v_cvt_pk_bf16_f32 v244, v144, v145
    v_cvt_pk_bf16_f32 v245, v146, v147
    v_cvt_pk_bf16_f32 v246, v148, v149
    v_cvt_pk_bf16_f32 v247, v150, v151
    s_add_u32 s97, s68, 1
    s_lshl_b32 s97, s97, 11
    s_add_u32 s97, s97, s71
    buffer_store_dwordx4 v[240:243], v1, s[20:23], s97 offen sc1
    buffer_store_dwordx4 v[244:247], v1, s[20:23], s97 offen offset:1024 sc1
    s_waitcnt vmcnt(11)
    s_mov_b64 exec, 0xff
    buffer_store_dword v109, v87, s[20:23], s78 offen offset:0 sc1
    s_mov_b64 exec, -1
    s_waitcnt lgkmcnt(0)
L_ATT:
    s_barrier
    ds_read_b128 v[22:25], v93 offset:4128
    ds_read_b128 v[26:29], v93 offset:5152
    ds_read_b128 v[30:33], v93 offset:33024
    ds_read_b128 v[34:37], v93 offset:34048
    ds_read_b128 v[78:81], v93 offset:0
    ds_read_b128 v[82:85], v93 offset:1024
    ds_read_b128 v[38:41], v94 offset:4128
    ds_read_b128 v[42:45], v94 offset:5168
    ds_read_b128 v[46:49], v95 offset:4128
    ds_read_b128 v[50:53], v95 offset:5168
    ds_read_b128 v[54:57], v94 offset:0
    ds_read_b128 v[58:61], v94 offset:1040
    ds_read_b128 v[62:65], v95 offset:0
    ds_read_b128 v[66:69], v95 offset:1040
    s_waitcnt lgkmcnt(13)
    v_mfma_f32_32x32x16_bf16 v[136:151], v[22:25], v[2:5], 0
    s_bfe_u32 s82, s61, 262168
    s_lshl_b32 s82, s82, 15
    s_add_u32 m0, s60, 98304
    s_add_u32 s82, s82, s3
    buffer_load_dwordx4 v18, s[32:35], s82 offen lds
    s_waitcnt lgkmcnt(12)
    v_mfma_f32_32x32x16_bf16 v[152:167], v[26:29], v[6:9], 0
    ds_read_b128 v[22:25], v93 offset:8256
    ds_read_b128 v[26:29], v93 offset:9280
    buffer_load_dwordx4 v19, s[32:35], s82 offen offset:1024 lds
    s_nop 1
    v_exp_f32 v136, v136
    v_exp_f32 v137, v137
    v_exp_f32 v138, v138
    v_exp_f32 v139, v139
    v_exp_f32 v140, v140
    s_waitcnt lgkmcnt(11)
    v_mfma_f32_32x32x16_bf16 v[168:183], v[78:81], v[2:5], 0
    buffer_load_dwordx4 v20, s[32:35], s82 offen offset:2048 lds
    v_exp_f32 v141, v141
    v_exp_f32 v142, v142
    v_exp_f32 v143, v143
    v_exp_f32 v144, v144
    v_exp_f32 v145, v145
    v_exp_f32 v146, v146
    s_waitcnt lgkmcnt(10)
    v_mfma_f32_32x32x16_bf16 v[184:199], v[82:85], v[6:9], 0
    buffer_load_dwordx4 v21, s[32:35], s82 offen offset:3072 lds
    v_exp_f32 v147, v147
    v_exp_f32 v148, v148
    v_exp_f32 v149, v149
    v_exp_f32 v150, v150
    v_exp_f32 v151, v151
    v_cvt_pk_bf16_f32 v232, v136, v137
    v_cvt_pk_bf16_f32 v233, v138, v139
    v_cvt_pk_bf16_f32 v234, v140, v141
    v_cvt_pk_bf16_f32 v235, v142, v143
    v_cvt_pk_bf16_f32 v236, v144, v145
    v_cvt_pk_bf16_f32 v237, v146, v147
    v_cvt_pk_bf16_f32 v238, v148, v149
    v_cvt_pk_bf16_f32 v239, v150, v151
    v_mfma_f32_32x32x16_bf16 v[136:151], v[30:33], v[2:5], 0
    s_add_u32 m0, s60, 131072
    s_add_u32 s82, s87, 32768
    buffer_load_dwordx4 v18, s[36:39], s82 offen lds
    v_exp_f32 v152, v152
    v_exp_f32 v153, v153
    v_exp_f32 v154, v154
    v_exp_f32 v155, v155
    v_exp_f32 v156, v156
    s_waitcnt lgkmcnt(9)
    v_mfma_f32_32x32x16_bf16 v[200:215], v[38:41], v[232:235], 0
    buffer_load_dwordx4 v19, s[36:39], s82 offen offset:1024 lds
    ds_read_b64_tr_b16 a[208:209], v102 offset:49152
    ds_read_b64_tr_b16 a[210:211], v102 offset:50176
    v_exp_f32 v157, v157
    v_exp_f32 v158, v158
    v_exp_f32 v159, v159
    v_exp_f32 v160, v160
    v_exp_f32 v161, v161
    v_exp_f32 v162, v162
    s_waitcnt lgkmcnt(10)
    v_mfma_f32_32x32x16_bf16 v[200:215], v[42:45], v[236:239], v[200:215]
    ds_read_b128 v[38:41], v94 offset:33024
    ds_read_b128 v[42:45], v94 offset:34064
    buffer_load_dwordx4 v20, s[36:39], s82 offen offset:2048 lds
    ds_read_b64_tr_b16 a[212:213], v103 offset:49152
    ds_read_b64_tr_b16 a[214:215], v103 offset:50176
    v_exp_f32 v163, v163
    v_exp_f32 v164, v164
    v_exp_f32 v165, v165
    v_exp_f32 v166, v166
    v_exp_f32 v167, v167
    v_cvt_pk_bf16_f32 v240, v152, v153
    v_cvt_pk_bf16_f32 v241, v154, v155
    v_cvt_pk_bf16_f32 v242, v156, v157
    v_cvt_pk_bf16_f32 v243, v158, v159
    v_cvt_pk_bf16_f32 v244, v160, v161
    v_cvt_pk_bf16_f32 v245, v162, v163
    v_cvt_pk_bf16_f32 v246, v164, v165
    v_cvt_pk_bf16_f32 v247, v166, v167
    v_mfma_f32_32x32x16_bf16 v[152:167], v[34:37], v[6:9], 0
    ds_read_b128 v[30:33], v93 offset:12384
    ds_read_b128 v[34:37], v93 offset:13408
    buffer_load_dwordx4 v21, s[36:39], s82 offen offset:3072 lds
    ds_read_b64_tr_b16 a[216:217], v102 offset:51200
    ds_read_b64_tr_b16 a[218:219], v102 offset:52224
    s_load_dwordx8 s[8:15], s[26:27], 0 glc
    v_bfi_b32 v136, v112, v168, v136
    v_bfi_b32 v137, v113, v169, v137
    v_bfi_b32 v138, v114, v170, v138
    v_bfi_b32 v139, v115, v171, v139
    v_bfi_b32 v140, v116, v172, v140
    v_bfi_b32 v141, v117, v173, v141
    v_bfi_b32 v142, v118, v174, v142
    v_bfi_b32 v143, v119, v175, v143
    s_waitcnt lgkmcnt(15)
    v_mfma_f32_32x32x16_bf16 v[216:231], v[46:49], v[240:243], 0
    s_add_u32 m0, s60, 147456
    s_add_u32 s82, s87, 65536
    buffer_load_dwordx4 v18, s[36:39], s82 offen lds
    ds_read_b64_tr_b16 a[220:221], v103 offset:51200
    v_bfi_b32 v144, v120, v176, v144
    v_bfi_b32 v145, v121, v177, v145
    v_bfi_b32 v146, v122, v178, v146
    v_bfi_b32 v147, v123, v179, v147
    v_bfi_b32 v148, v124, v180, v148
    v_bfi_b32 v149, v125, v181, v149
    v_bfi_b32 v150, v126, v182, v150
    v_bfi_b32 v151, v127, v183, v151
    s_waitcnt lgkmcnt(15)
    v_mfma_f32_32x32x16_bf16 v[216:231], v[50:53], v[244:247], v[216:231]
    ds_read_b128 v[46:49], v95 offset:33024
    ds_read_b128 v[50:53], v95 offset:34064
    buffer_load_dwordx4 v19, s[36:39], s82 offen offset:1024 lds
    ds_read_b64_tr_b16 a[222:223], v103 offset:52224
    s_waitcnt vmcnt(17)
    ds_read_b64_tr_b16 a[224:225], v102 offset:0
    v_exp_f32 v136, v136
    v_exp_f32 v137, v137
    v_exp_f32 v138, v138
    v_exp_f32 v139, v139
    v_exp_f32 v140, v140
    v_exp_f32 v141, v141
    v_exp_f32 v142, v142
    v_exp_f32 v143, v143
    v_exp_f32 v144, v144
    v_exp_f32 v145, v145
    v_exp_f32 v146, v146
    v_exp_f32 v147, v147
    v_exp_f32 v148, v148
    v_exp_f32 v149, v149
    v_exp_f32 v150, v150
    v_exp_f32 v151, v151
    v_cvt_pk_bf16_f32 v232, v136, v137
    v_cvt_pk_bf16_f32 v233, v138, v139
    v_cvt_pk_bf16_f32 v234, v140, v141
    v_cvt_pk_bf16_f32 v235, v142, v143
    v_cvt_pk_bf16_f32 v236, v144, v145
    v_cvt_pk_bf16_f32 v237, v146, v147
    v_cvt_pk_bf16_f32 v238, v148, v149
    v_cvt_pk_bf16_f32 v239, v150, v151
    s_waitcnt lgkmcnt(15)
    v_mfma_f32_32x32x16_bf16 v[136:151], v[22:25], v[2:5], 0
    buffer_load_dwordx4 v20, s[36:39], s82 offen offset:2048 lds
    ds_read_b64_tr_b16 a[226:227], v102 offset:1024
    ds_read_b64_tr_b16 a[228:229], v103 offset:0
    v_and_b32 v248, v128, v232
    v_bfi_b32 v232, v128, 0, v232
    v_and_b32 v249, v129, v233
    v_bfi_b32 v233, v129, 0, v233
    v_and_b32 v250, v130, v234
    v_bfi_b32 v234, v130, 0, v234
    v_and_b32 v251, v131, v235
    v_bfi_b32 v235, v131, 0, v235
    v_and_b32 v252, v132, v236
    v_bfi_b32 v236, v132, 0, v236
    v_and_b32 v253, v133, v237
    v_bfi_b32 v237, v133, 0, v237
    v_and_b32 v254, v134, v238
    v_bfi_b32 v238, v134, 0, v238
    v_and_b32 v255, v135, v239
    v_bfi_b32 v239, v135, 0, v239
    v_bfi_b32 v152, v112, v184, v152
    v_bfi_b32 v153, v113, v185, v153
    v_bfi_b32 v154, v114, v186, v154
    v_bfi_b32 v155, v115, v187, v155
    v_bfi_b32 v156, v116, v188, v156
    v_bfi_b32 v157, v117, v189, v157
    v_bfi_b32 v158, v118, v190, v158
    v_bfi_b32 v159, v119, v191, v159
    s_waitcnt lgkmcnt(14)
    v_mfma_f32_32x32x16_bf16 v[200:215], v[38:41], v[232:235], v[200:215]
    buffer_load_dwordx4 v21, s[36:39], s82 offen offset:3072 lds
    ds_read_b64_tr_b16 a[230:231], v103 offset:1024
    ds_read_b64_tr_b16 a[232:233], v102 offset:2048
    v_bfi_b32 v160, v120, v192, v160
    v_bfi_b32 v161, v121, v193, v161
    v_bfi_b32 v162, v122, v194, v162
    v_bfi_b32 v163, v123, v195, v163
    v_bfi_b32 v164, v124, v196, v164
    v_bfi_b32 v165, v125, v197, v165
    v_bfi_b32 v166, v126, v198, v166
    v_bfi_b32 v167, v127, v199, v167
    s_waitcnt lgkmcnt(15)
    v_mfma_f32_32x32x16_bf16 v[200:215], v[42:45], v[236:239], v[200:215]
    ds_read_b128 v[38:41], v94 offset:8256
    ds_read_b128 v[42:45], v94 offset:9296
    ds_read_b64_tr_b16 a[234:235], v102 offset:3072
    ds_read_b64_tr_b16 a[236:237], v103 offset:2048
    v_exp_f32 v152, v152
    v_exp_f32 v153, v153
    v_exp_f32 v154, v154
    v_exp_f32 v155, v155
    v_exp_f32 v156, v156
    v_mfma_f32_32x32x16_bf16 v[200:215], v[54:57], v[248:251], v[200:215]
    ds_read_b64_tr_b16 a[238:239], v103 offset:3072
    s_waitcnt vmcnt(15)
    ds_read_b64_tr_b16 a[240:241], v102 offset:16384
    v_exp_f32 v157, v157
    v_exp_f32 v158, v158
    v_exp_f32 v159, v159
    v_exp_f32 v160, v160
    v_exp_f32 v161, v161
    v_exp_f32 v162, v162
    v_mfma_f32_32x32x16_bf16 v[200:215], v[58:61], v[252:255], v[200:215]
    s_waitcnt vmcnt(12)
    s_mov_b64 exec, 0xff
    buffer_store_dword v109, v87, s[20:23], s78 offen offset:32 sc1
    s_mov_b64 exec, -1
    v_exp_f32 v163, v163
    v_exp_f32 v164, v164
    v_exp_f32 v165, v165
    v_exp_f32 v166, v166
    v_exp_f32 v167, v167
    v_cvt_pk_bf16_f32 v240, v152, v153
    v_cvt_pk_bf16_f32 v241, v154, v155
    v_cvt_pk_bf16_f32 v242, v156, v157
    v_cvt_pk_bf16_f32 v243, v158, v159
    v_cvt_pk_bf16_f32 v244, v160, v161
    v_cvt_pk_bf16_f32 v245, v162, v163
    v_cvt_pk_bf16_f32 v246, v164, v165
    v_cvt_pk_bf16_f32 v247, v166, v167
    v_mfma_f32_32x32x16_bf16 v[152:167], v[26:29], v[6:9], 0
    ds_read_b128 v[22:25], v93 offset:16512
    ds_read_b128 v[26:29], v93 offset:17536
    ds_read_b64_tr_b16 a[242:243], v102 offset:17408
    ds_read_b64_tr_b16 a[244:245], v103 offset:16384
    v_and_b32 v70, v128, v240
    v_bfi_b32 v240, v128, 0, v240
    v_and_b32 v71, v129, v241
    v_bfi_b32 v241, v129, 0, v241
    v_and_b32 v72, v130, v242
    v_bfi_b32 v242, v130, 0, v242
    v_and_b32 v73, v131, v243
    v_bfi_b32 v243, v131, 0, v243
    v_and_b32 v74, v132, v244
    v_bfi_b32 v244, v132, 0, v244
    v_and_b32 v75, v133, v245
    v_bfi_b32 v245, v133, 0, v245
    v_and_b32 v76, v134, v246
    v_bfi_b32 v246, v134, 0, v246
    v_and_b32 v77, v135, v247
    v_bfi_b32 v247, v135, 0, v247
    s_waitcnt lgkmcnt(0)
    s_cmp_eq_u64 s[8:9], s[28:29]
    s_cbranch_scc0 L_PH_S
    s_cmp_eq_u64 s[10:11], s[28:29]
    s_cbranch_scc0 L_PH_S
    s_cmp_eq_u64 s[12:13], s[28:29]
    s_cbranch_scc0 L_PH_S
    s_cmp_eq_u64 s[14:15], s[28:29]
    s_cbranch_scc0 L_PH_S
L_PH_R:
    v_exp_f32 v136, v136
    v_exp_f32 v137, v137
    v_exp_f32 v138, v138
    v_exp_f32 v139, v139
    v_mfma_f32_32x32x16_bf16 v[216:231], v[46:49], v[240:243], v[216:231]
    s_bfe_u32 s58, s61, 262144
    s_lshl_b32 s58, s58, 11
    s_add_u32 s58, s58, s75
    s_add_u32 s57, s58, s84
    s_add_u32 s58, s58, s85
    buffer_load_dwordx4 a[0:3], v1, s[20:23], s57 offen offset:0 sc1
    v_exp_f32 v140, v140
    v_exp_f32 v141, v141
    v_exp_f32 v142, v142
    v_exp_f32 v143, v143
    v_mfma_f32_32x32x16_bf16 v[216:231], v[50:53], v[244:247], v[216:231]
    ds_read_b128 v[46:49], v95 offset:8256
    ds_read_b128 v[50:53], v95 offset:9296
    buffer_load_dwordx4 a[4:7], v1, s[20:23], s58 offen offset:0 sc1
    ds_read_b64_tr_b16 a[246:247], v103 offset:17408
    ds_read_b64_tr_b16 a[248:249], v102 offset:18432
    v_exp_f32 v144, v144
    v_exp_f32 v145, v145
    v_exp_f32 v146, v146
    v_exp_f32 v147, v147
    v_mfma_f32_32x32x16_bf16 v[216:231], v[62:65], v[70:73], v[216:231]
    buffer_load_dwordx4 a[8:11], v1, s[20:23], s57 offen offset:1024 sc1
    ds_read_b64_tr_b16 a[250:251], v102 offset:19456
    ds_read_b64_tr_b16 a[252:253], v103 offset:18432
    v_exp_f32 v148, v148
    v_exp_f32 v149, v149
    v_exp_f32 v150, v150
    v_exp_f32 v151, v151
    v_mfma_f32_32x32x16_bf16 v[216:231], v[66:69], v[74:77], v[216:231]
    buffer_load_dwordx4 a[12:15], v1, s[20:23], s58 offen offset:1024 sc1
    ds_read_b64_tr_b16 a[254:255], v103 offset:19456
    s_waitcnt vmcnt(13)
    ds_read_b64_tr_b16 a[144:145], v102 offset:32768
    v_cvt_pk_bf16_f32 v232, v136, v137
    v_cvt_pk_bf16_f32 v233, v138, v139
    v_cvt_pk_bf16_f32 v234, v140, v141
    v_cvt_pk_bf16_f32 v235, v142, v143
    v_cvt_pk_bf16_f32 v236, v144, v145
    v_cvt_pk_bf16_f32 v237, v146, v147
    v_cvt_pk_bf16_f32 v238, v148, v149
    v_cvt_pk_bf16_f32 v239, v150, v151
    v_mfma_f32_32x32x16_bf16 v[136:151], v[30:33], v[2:5], 0
    buffer_load_dwordx4 a[16:19], v1, s[20:23], s57 offen offset:2048 sc1
    ds_read_b64_tr_b16 a[146:147], v102 offset:33792
    ds_read_b64_tr_b16 a[148:149], v103 offset:32768
    buffer_load_dwordx4 a[20:23], v1, s[20:23], s58 offen offset:2048 sc1
    v_exp_f32 v152, v152
    v_exp_f32 v153, v153
    v_exp_f32 v154, v154
    v_exp_f32 v155, v155
    v_exp_f32 v156, v156
    v_mfma_f32_32x32x16_bf16 v[200:215], v[38:41], v[232:235], v[200:215]
    buffer_load_dwordx4 a[24:27], v1, s[20:23], s57 offen offset:3072 sc1
    ds_read_b64_tr_b16 a[150:151], v103 offset:33792
    ds_read_b64_tr_b16 a[152:153], v102 offset:34816
    v_exp_f32 v157, v157
    v_exp_f32 v158, v158
    v_exp_f32 v159, v159
    v_exp_f32 v160, v160
    v_exp_f32 v161, v161
    v_exp_f32 v162, v162
    v_mfma_f32_32x32x16_bf16 v[200:215], v[42:45], v[236:239], v[200:215]
    ds_read_b128 v[38:41], v94 offset:12384
    ds_read_b128 v[42:45], v94 offset:13424
    buffer_load_dwordx4 a[28:31], v1, s[20:23], s58 offen offset:3072 sc1
    ds_read_b64_tr_b16 a[154:155], v102 offset:35840
    ds_read_b64_tr_b16 a[156:157], v103 offset:34816
    v_exp_f32 v163, v163
    v_exp_f32 v164, v164
    v_exp_f32 v165, v165
    v_exp_f32 v166, v166
    v_exp_f32 v167, v167
    v_cvt_pk_bf16_f32 v240, v152, v153
    v_cvt_pk_bf16_f32 v241, v154, v155
    v_cvt_pk_bf16_f32 v242, v156, v157
    v_cvt_pk_bf16_f32 v243, v158, v159
    v_cvt_pk_bf16_f32 v244, v160, v161
    v_cvt_pk_bf16_f32 v245, v162, v163
    v_cvt_pk_bf16_f32 v246, v164, v165
    v_cvt_pk_bf16_f32 v247, v166, v167
    v_mfma_f32_32x32x16_bf16 v[152:167], v[34:37], v[6:9], 0
    ds_read_b128 v[30:33], v93 offset:20640
    ds_read_b128 v[34:37], v93 offset:21664
    s_bfe_u32 s58, s61, 262152
    s_lshl_b32 s58, s58, 11
    s_add_u32 s58, s58, s75
    s_add_u32 s57, s58, s84
    s_add_u32 s58, s58, s85
    buffer_load_dwordx4 a[32:35], v1, s[20:23], s57 offen offset:0 sc1
    buffer_load_dwordx4 a[36:39], v1, s[20:23], s58 offen offset:0 sc1
    v_exp_f32 v136, v136
    v_exp_f32 v137, v137
    v_exp_f32 v138, v138
    v_exp_f32 v139, v139
    v_exp_f32 v140, v140
    s_waitcnt lgkmcnt(15)
    v_mfma_f32_32x32x16_bf16 v[216:231], v[46:49], v[240:243], v[216:231]
    buffer_load_dwordx4 a[40:43], v1, s[20:23], s57 offen offset:1024 sc1
    ds_read_b64_tr_b16 a[158:159], v103 offset:35840
    v_exp_f32 v141, v141
    v_exp_f32 v142, v142
    v_exp_f32 v143, v143
    v_exp_f32 v144, v144
    v_exp_f32 v145, v145
    v_exp_f32 v146, v146
    s_waitcnt lgkmcnt(15)
    v_mfma_f32_32x32x16_bf16 v[216:231], v[50:53], v[244:247], v[216:231]
    ds_read_b128 v[46:49], v95 offset:12384
    ds_read_b128 v[50:53], v95 offset:13424
    buffer_load_dwordx4 a[44:47], v1, s[20:23], s58 offen offset:1024 sc1
    v_exp_f32 v147, v147
    v_exp_f32 v148, v148
    v_exp_f32 v149, v149
    v_exp_f32 v150, v150
    v_exp_f32 v151, v151
    v_cvt_pk_bf16_f32 v232, v136, v137
    v_cvt_pk_bf16_f32 v233, v138, v139
    v_cvt_pk_bf16_f32 v234, v140, v141
    v_cvt_pk_bf16_f32 v235, v142, v143
    v_cvt_pk_bf16_f32 v236, v144, v145
    v_cvt_pk_bf16_f32 v237, v146, v147
    v_cvt_pk_bf16_f32 v238, v148, v149
    v_cvt_pk_bf16_f32 v239, v150, v151
    v_mfma_f32_32x32x16_bf16 v[136:151], v[22:25], v[2:5], 0
    buffer_load_dwordx4 a[48:51], v1, s[20:23], s57 offen offset:2048 sc1
    buffer_load_dwordx4 a[52:55], v1, s[20:23], s58 offen offset:2048 sc1
    s_load_dwordx8 s[8:15], s[26:27], 32 glc
    v_exp_f32 v152, v152
    v_exp_f32 v153, v153
    v_exp_f32 v154, v154
    v_exp_f32 v155, v155
    v_exp_f32 v156, v156
    s_waitcnt lgkmcnt(8)
    v_mfma_f32_32x32x16_bf16 v[200:215], v[38:41], v[232:235], v[200:215]
    buffer_load_dwordx4 a[56:59], v1, s[20:23], s57 offen offset:3072 sc1
    v_exp_f32 v157, v157
    v_exp_f32 v158, v158
    v_exp_f32 v159, v159
    v_exp_f32 v160, v160
    v_exp_f32 v161, v161
    v_exp_f32 v162, v162
    s_waitcnt lgkmcnt(7)
    v_mfma_f32_32x32x16_bf16 v[200:215], v[42:45], v[236:239], v[200:215]
    ds_read_b128 v[38:41], v94 offset:16512
    ds_read_b128 v[42:45], v94 offset:17552
    buffer_load_dwordx4 a[60:63], v1, s[20:23], s58 offen offset:3072 sc1
    v_exp_f32 v163, v163
    v_exp_f32 v164, v164
    v_exp_f32 v165, v165
    v_exp_f32 v166, v166
    v_exp_f32 v167, v167
    v_cvt_pk_bf16_f32 v240, v152, v153
    v_cvt_pk_bf16_f32 v241, v154, v155
    v_cvt_pk_bf16_f32 v242, v156, v157
    v_cvt_pk_bf16_f32 v243, v158, v159
    v_cvt_pk_bf16_f32 v244, v160, v161
    v_cvt_pk_bf16_f32 v245, v162, v163
    v_cvt_pk_bf16_f32 v246, v164, v165
    v_cvt_pk_bf16_f32 v247, v166, v167
    v_mfma_f32_32x32x16_bf16 v[152:167], v[26:29], v[6:9], 0
    ds_read_b128 v[22:25], v93 offset:24768
    ds_read_b128 v[26:29], v93 offset:25792
    s_bfe_u32 s58, s61, 262144
    s_lshl_b32 s58, s58, 11
    s_add_u32 s57, s58, s84
    s_add_u32 s58, s58, s85
    buffer_load_dwordx4 a[64:67], v1, s[20:23], s57 offen offset:0 sc1
    buffer_load_dwordx4 a[68:71], v1, s[20:23], s58 offen offset:0 sc1
    v_exp_f32 v136, v136
    v_exp_f32 v137, v137
    v_exp_f32 v138, v138
    v_exp_f32 v139, v139
    v_exp_f32 v140, v140
    s_waitcnt lgkmcnt(5)
    v_mfma_f32_32x32x16_bf16 v[216:231], v[46:49], v[240:243], v[216:231]
    buffer_load_dwordx4 a[72:75], v1, s[20:23], s57 offen offset:1024 sc1
    v_exp_f32 v141, v141
    v_exp_f32 v142, v142
    v_exp_f32 v143, v143
    v_exp_f32 v144, v144
    v_exp_f32 v145, v145
    v_exp_f32 v146, v146
    s_waitcnt lgkmcnt(4)
    v_mfma_f32_32x32x16_bf16 v[216:231], v[50:53], v[244:247], v[216:231]
    ds_read_b128 v[46:49], v95 offset:16512
    ds_read_b128 v[50:53], v95 offset:17552
    buffer_load_dwordx4 a[76:79], v1, s[20:23], s58 offen offset:1024 sc1
    v_exp_f32 v147, v147
    v_exp_f32 v148, v148
    v_exp_f32 v149, v149
    v_exp_f32 v150, v150
    v_exp_f32 v151, v151
    v_cvt_pk_bf16_f32 v232, v136, v137
    v_cvt_pk_bf16_f32 v233, v138, v139
    v_cvt_pk_bf16_f32 v234, v140, v141
    v_cvt_pk_bf16_f32 v235, v142, v143
    v_cvt_pk_bf16_f32 v236, v144, v145
    v_cvt_pk_bf16_f32 v237, v146, v147
    v_cvt_pk_bf16_f32 v238, v148, v149
    v_cvt_pk_bf16_f32 v239, v150, v151
    v_mfma_f32_32x32x16_bf16 v[136:151], v[30:33], v[2:5], 0
    buffer_load_dwordx4 a[80:83], v1, s[20:23], s57 offen offset:2048 sc1
    buffer_load_dwordx4 a[84:87], v1, s[20:23], s58 offen offset:2048 sc1
    s_waitcnt lgkmcnt(0)
    s_cmp_eq_u64 s[8:9], s[28:29]
    s_cbranch_scc0 L_PH2_S
    s_cmp_eq_u64 s[10:11], s[28:29]
    s_cbranch_scc0 L_PH2_S
    s_cmp_eq_u64 s[12:13], s[28:29]
    s_cbranch_scc0 L_PH2_S
    s_cmp_eq_u64 s[14:15], s[28:29]
    s_cbranch_scc0 L_PH2_S
L_PH2_R:
    v_exp_f32 v152, v152
    v_exp_f32 v153, v153
    v_exp_f32 v154, v154
    v_exp_f32 v155, v155
    v_exp_f32 v156, v156
    v_mfma_f32_32x32x16_bf16 v[200:215], v[38:41], v[232:235], v[200:215]
    buffer_load_dwordx4 a[88:91], v1, s[20:23], s57 offen offset:3072 sc1
    v_exp_f32 v157, v157
    v_exp_f32 v158, v158
    v_exp_f32 v159, v159
    v_exp_f32 v160, v160
    v_exp_f32 v161, v161
    v_exp_f32 v162, v162
    v_mfma_f32_32x32x16_bf16 v[200:215], v[42:45], v[236:239], v[200:215]
    ds_read_b128 v[38:41], v94 offset:20640
    ds_read_b128 v[42:45], v94 offset:21680
    buffer_load_dwordx4 a[92:95], v1, s[20:23], s58 offen offset:3072 sc1
    v_exp_f32 v163, v163
    v_exp_f32 v164, v164
    v_exp_f32 v165, v165
    v_exp_f32 v166, v166
    v_exp_f32 v167, v167
    v_cvt_pk_bf16_f32 v240, v152, v153
    v_cvt_pk_bf16_f32 v241, v154, v155
    v_cvt_pk_bf16_f32 v242, v156, v157
    v_cvt_pk_bf16_f32 v243, v158, v159
    v_cvt_pk_bf16_f32 v244, v160, v161
    v_cvt_pk_bf16_f32 v245, v162, v163
    v_cvt_pk_bf16_f32 v246, v164, v165
    v_cvt_pk_bf16_f32 v247, v166, v167
    v_mfma_f32_32x32x16_bf16 v[152:167], v[34:37], v[6:9], 0
    ds_read_b128 v[30:33], v93 offset:28896
    ds_read_b128 v[34:37], v93 offset:29920
    s_bfe_u32 s58, s61, 262152
    s_lshl_b32 s58, s58, 11
    s_add_u32 s57, s58, s84
    s_add_u32 s58, s58, s85
    buffer_load_dwordx4 a[96:99], v1, s[20:23], s57 offen offset:0 sc1
    buffer_load_dwordx4 a[100:103], v1, s[20:23], s58 offen offset:0 sc1
    v_exp_f32 v136, v136
    v_exp_f32 v137, v137
    v_exp_f32 v138, v138
    v_exp_f32 v139, v139
    v_exp_f32 v140, v140
    v_mfma_f32_32x32x16_bf16 v[216:231], v[46:49], v[240:243], v[216:231]
    buffer_load_dwordx4 a[104:107], v1, s[20:23], s57 offen offset:1024 sc1
    v_exp_f32 v141, v141
    v_exp_f32 v142, v142
    v_exp_f32 v143, v143
    v_exp_f32 v144, v144
    v_exp_f32 v145, v145
    v_exp_f32 v146, v146
    v_mfma_f32_32x32x16_bf16 v[216:231], v[50:53], v[244:247], v[216:231]
    ds_read_b128 v[46:49], v95 offset:20640
    ds_read_b128 v[50:53], v95 offset:21680
    buffer_load_dwordx4 a[108:111], v1, s[20:23], s58 offen offset:1024 sc1
    v_exp_f32 v147, v147
    v_exp_f32 v148, v148
    v_exp_f32 v149, v149
    v_exp_f32 v150, v150
    v_exp_f32 v151, v151
    v_cvt_pk_bf16_f32 v232, v136, v137
    v_cvt_pk_bf16_f32 v233, v138, v139
    v_cvt_pk_bf16_f32 v234, v140, v141
    v_cvt_pk_bf16_f32 v235, v142, v143
    v_cvt_pk_bf16_f32 v236, v144, v145
    v_cvt_pk_bf16_f32 v237, v146, v147
    v_cvt_pk_bf16_f32 v238, v148, v149
    v_cvt_pk_bf16_f32 v239, v150, v151
    v_mfma_f32_32x32x16_bf16 v[136:151], v[22:25], v[2:5], 0
    buffer_load_dwordx4 a[112:115], v1, s[20:23], s57 offen offset:2048 sc1
    buffer_load_dwordx4 a[116:119], v1, s[20:23], s58 offen offset:2048 sc1
    v_exp_f32 v152, v152
    v_exp_f32 v153, v153
    v_exp_f32 v154, v154
    v_exp_f32 v155, v155
    v_exp_f32 v156, v156
    s_waitcnt lgkmcnt(5)
    v_mfma_f32_32x32x16_bf16 v[200:215], v[38:41], v[232:235], v[200:215]
    buffer_load_dwordx4 a[120:123], v1, s[20:23], s57 offen offset:3072 sc1
    v_exp_f32 v157, v157
    v_exp_f32 v158, v158
    v_exp_f32 v159, v159
    v_exp_f32 v160, v160
    v_exp_f32 v161, v161
    v_exp_f32 v162, v162
    s_waitcnt lgkmcnt(4)
    v_mfma_f32_32x32x16_bf16 v[200:215], v[42:45], v[236:239], v[200:215]
    ds_read_b128 v[38:41], v94 offset:24768
    ds_read_b128 v[42:45], v94 offset:25808
    buffer_load_dwordx4 a[124:127], v1, s[20:23], s58 offen offset:3072 sc1
    v_exp_f32 v163, v163
    v_exp_f32 v164, v164
    v_exp_f32 v165, v165
    v_exp_f32 v166, v166
    v_exp_f32 v167, v167
    v_cvt_pk_bf16_f32 v240, v152, v153
    v_cvt_pk_bf16_f32 v241, v154, v155
    v_cvt_pk_bf16_f32 v242, v156, v157
    v_cvt_pk_bf16_f32 v243, v158, v159
    v_cvt_pk_bf16_f32 v244, v160, v161
    v_cvt_pk_bf16_f32 v245, v162, v163
    v_cvt_pk_bf16_f32 v246, v164, v165
    v_cvt_pk_bf16_f32 v247, v166, v167
    v_mfma_f32_32x32x16_bf16 v[152:167], v[26:29], v[6:9], 0
    s_bfe_u32 s58, s61, 262160
    s_lshl_b32 s58, s58, 11
    s_add_u32 s58, s58, s75
    s_add_u32 s57, s58, s84
    s_add_u32 s58, s58, s85
    buffer_load_dwordx4 a[128:131], v1, s[20:23], s57 offen offset:0 sc1
    buffer_load_dwordx4 a[132:135], v1, s[20:23], s58 offen offset:0 sc1
    v_exp_f32 v136, v136
    v_exp_f32 v137, v137
    v_exp_f32 v138, v138
    v_exp_f32 v139, v139
    v_exp_f32 v140, v140
    s_waitcnt lgkmcnt(3)
    v_mfma_f32_32x32x16_bf16 v[216:231], v[46:49], v[240:243], v[216:231]
    buffer_load_dwordx4 a[136:139], v1, s[20:23], s57 offen offset:1024 sc1
    v_exp_f32 v141, v141
    v_exp_f32 v142, v142
    v_exp_f32 v143, v143
    v_exp_f32 v144, v144
    v_exp_f32 v145, v145
    v_exp_f32 v146, v146
    s_waitcnt lgkmcnt(2)
    v_mfma_f32_32x32x16_bf16 v[216:231], v[50:53], v[244:247], v[216:231]
    ds_read_b128 v[46:49], v95 offset:24768
    ds_read_b128 v[50:53], v95 offset:25808
    buffer_load_dwordx4 a[140:143], v1, s[20:23], s58 offen offset:1024 sc1
    v_exp_f32 v147, v147
    v_exp_f32 v148, v148
    v_exp_f32 v149, v149
    v_exp_f32 v150, v150
    v_exp_f32 v151, v151
    v_cvt_pk_bf16_f32 v232, v136, v137
    v_cvt_pk_bf16_f32 v233, v138, v139
    v_cvt_pk_bf16_f32 v234, v140, v141
    v_cvt_pk_bf16_f32 v235, v142, v143
    v_cvt_pk_bf16_f32 v236, v144, v145
    v_cvt_pk_bf16_f32 v237, v146, v147
    v_cvt_pk_bf16_f32 v238, v148, v149
    v_cvt_pk_bf16_f32 v239, v150, v151
    v_mfma_f32_32x32x16_bf16 v[136:151], v[30:33], v[2:5], 0
    buffer_load_dwordx4 v[54:57], v1, s[20:23], s57 offen offset:2048 sc1
    buffer_load_dwordx4 v[58:61], v1, s[20:23], s58 offen offset:2048 sc1
    v_exp_f32 v152, v152
    v_exp_f32 v153, v153
    v_exp_f32 v154, v154
    v_exp_f32 v155, v155
    v_exp_f32 v156, v156
    s_waitcnt lgkmcnt(3)
    v_mfma_f32_32x32x16_bf16 v[200:215], v[38:41], v[232:235], v[200:215]
    buffer_load_dwordx4 v[62:65], v1, s[20:23], s57 offen offset:3072 sc1
    v_exp_f32 v157, v157
    v_exp_f32 v158, v158
    v_exp_f32 v159, v159
    v_exp_f32 v160, v160
    v_exp_f32 v161, v161
    v_exp_f32 v162, v162
    s_waitcnt lgkmcnt(2)
    v_mfma_f32_32x32x16_bf16 v[200:215], v[42:45], v[236:239], v[200:215]
    ds_read_b128 v[38:41], v94 offset:28896
    ds_read_b128 v[42:45], v94 offset:29936
    buffer_load_dwordx4 v[66:69], v1, s[20:23], s58 offen offset:3072 sc1
    v_exp_f32 v163, v163
    v_exp_f32 v164, v164
    v_exp_f32 v165, v165
    v_exp_f32 v166, v166
    v_exp_f32 v167, v167
    v_cvt_pk_bf16_f32 v240, v152, v153
    v_cvt_pk_bf16_f32 v241, v154, v155
    v_cvt_pk_bf16_f32 v242, v156, v157
    v_cvt_pk_bf16_f32 v243, v158, v159
    v_cvt_pk_bf16_f32 v244, v160, v161
    v_cvt_pk_bf16_f32 v245, v162, v163
    v_cvt_pk_bf16_f32 v246, v164, v165
    v_cvt_pk_bf16_f32 v247, v166, v167
    v_mfma_f32_32x32x16_bf16 v[152:167], v[34:37], v[6:9], 0
    s_bfe_u32 s58, s61, 262168
    s_lshl_b32 s58, s58, 11
    s_add_u32 s58, s58, s75
    s_add_u32 s57, s58, s84
    s_add_u32 s58, s58, s85
    buffer_load_dwordx4 v[70:73], v1, s[20:23], s57 offen offset:0 sc1
    buffer_load_dwordx4 v[74:77], v1, s[20:23], s58 offen offset:0 sc1
    v_exp_f32 v136, v136
    v_exp_f32 v137, v137
    v_exp_f32 v138, v138
    v_exp_f32 v139, v139
    v_exp_f32 v140, v140
    s_waitcnt lgkmcnt(3)
    v_mfma_f32_32x32x16_bf16 v[216:231], v[46:49], v[240:243], v[216:231]
    buffer_load_dwordx4 v[78:81], v1, s[20:23], s57 offen offset:1024 sc1
    v_exp_f32 v141, v141
    v_exp_f32 v142, v142
    v_exp_f32 v143, v143
    v_exp_f32 v144, v144
    v_exp_f32 v145, v145
    v_exp_f32 v146, v146
    s_waitcnt lgkmcnt(2)
    v_mfma_f32_32x32x16_bf16 v[216:231], v[50:53], v[244:247], v[216:231]
    ds_read_b128 v[46:49], v95 offset:28896
    ds_read_b128 v[50:53], v95 offset:29936
    buffer_load_dwordx4 v[82:85], v1, s[20:23], s58 offen offset:1024 sc1
    v_exp_f32 v147, v147
    v_exp_f32 v148, v148
    v_exp_f32 v149, v149
    v_exp_f32 v150, v150
    v_exp_f32 v151, v151
    v_cvt_pk_bf16_f32 v232, v136, v137
    v_cvt_pk_bf16_f32 v233, v138, v139
    v_cvt_pk_bf16_f32 v234, v140, v141
    v_cvt_pk_bf16_f32 v235, v142, v143
    v_cvt_pk_bf16_f32 v236, v144, v145
    v_cvt_pk_bf16_f32 v237, v146, v147
    v_cvt_pk_bf16_f32 v238, v148, v149
    v_cvt_pk_bf16_f32 v239, v150, v151
    v_exp_f32 v152, v152
    v_exp_f32 v153, v153
    v_exp_f32 v154, v154
    v_exp_f32 v155, v155
    v_exp_f32 v156, v156
    s_waitcnt lgkmcnt(3)
    v_mfma_f32_32x32x16_bf16 v[200:215], v[38:41], v[232:235], v[200:215]
    s_add_u32 m0, s60, 114688
    s_add_u32 s82, s87, 0
    buffer_load_dwordx4 v18, s[36:39], s82 offen lds
    v_exp_f32 v157, v157
    v_exp_f32 v158, v158
    v_exp_f32 v159, v159
    v_exp_f32 v160, v160
    v_exp_f32 v161, v161
    v_exp_f32 v162, v162
    s_waitcnt lgkmcnt(2)
    v_mfma_f32_32x32x16_bf16 v[200:215], v[42:45], v[236:239], v[200:215]
    buffer_load_dwordx4 v19, s[36:39], s82 offen offset:1024 lds
    v_exp_f32 v163, v163
    v_exp_f32 v164, v164
    v_exp_f32 v165, v165
    v_exp_f32 v166, v166
    v_exp_f32 v167, v167
    v_cvt_pk_bf16_f32 v240, v152, v153
    v_cvt_pk_bf16_f32 v241, v154, v155
    v_cvt_pk_bf16_f32 v242, v156, v157
    v_cvt_pk_bf16_f32 v243, v158, v159
    v_cvt_pk_bf16_f32 v244, v160, v161
    v_cvt_pk_bf16_f32 v245, v162, v163
    v_cvt_pk_bf16_f32 v246, v164, v165
    v_cvt_pk_bf16_f32 v247, v166, v167
    s_mov_b64 s[100:101], -1
    s_mul_i32 s98, s54, 2048
    s_waitcnt lgkmcnt(1)
    v_mfma_f32_32x32x16_bf16 v[216:231], v[46:49], v[240:243], v[216:231]
    buffer_load_dwordx4 v20, s[36:39], s82 offen offset:2048 lds
    s_waitcnt lgkmcnt(0)
    v_mfma_f32_32x32x16_bf16 v[216:231], v[50:53], v[244:247], v[216:231]
    buffer_load_dwordx4 v21, s[36:39], s82 offen offset:3072 lds
    s_add_u32 s98, s98, s71
    s_add_u32 s98, s98, 114688
L_FBR:
    s_waitcnt vmcnt(32)
    v_mfma_f32_32x32x16_bf16 v[152:167], a[164:167], a[0:3], 0
    v_rcp_f32 v209, v208
    s_nop 0
    v_mul_f32 v209, v209, v90
    v_mul_f32 v200, v209, v200
    v_mul_f32 v201, v209, v201
    v_cvt_pk_bf16_f32 v232, v200, v201
    v_mfma_f32_32x32x16_bf16 v[152:167], a[172:175], a[8:11], v[152:167]
    v_mul_f32 v202, v209, v202
    v_mul_f32 v203, v209, v203
    v_cvt_pk_bf16_f32 v233, v202, v203
    v_mul_f32 v204, v209, v204
    v_mul_f32 v205, v209, v205
    v_mfma_f32_32x32x16_bf16 v[152:167], a[180:183], a[16:19], v[152:167]
    v_cvt_pk_bf16_f32 v234, v204, v205
    v_mul_f32 v206, v209, v206
    v_mul_f32 v207, v209, v207
    v_cvt_pk_bf16_f32 v235, v206, v207
    v_mfma_f32_32x32x16_bf16 v[152:167], a[188:191], a[24:27], v[152:167]
    s_mov_b32 s94, 0x21800000
    s_mov_b32 s95, 0x4e800000
    v_min_f32 v210, v208, v224
    v_add_f32 v211, v208, v224
    v_cmp_nle_f32 vcc, s94, v210
    v_cmp_nge_f32 s[96:97], s95, v211
    s_nop 0
    s_or_b64 vcc, vcc, s[96:97]
    s_and_b64 vcc, vcc, s[100:101]
    s_cbranch_scc1 L_FB
    buffer_store_dwordx4 v[232:235], v1, s[20:23], s98 offen offset:0 sc1
    v_mfma_f32_32x32x16_bf16 v[152:167], a[196:199], a[32:35], v[152:167]
    s_add_u32 m0, s60, 65536
    s_add_u32 s82, s87, 98304
    buffer_load_dwordx4 v18, s[36:39], s82 offen lds
    v_mfma_f32_32x32x16_bf16 v[152:167], a[204:207], a[40:43], v[152:167]
    v_rcp_f32 v225, v224
    s_nop 0
    v_mul_f32 v225, v225, v90
    v_mul_f32 v216, v225, v216
    v_mfma_f32_32x32x16_bf16 v[152:167], a[212:215], a[48:51], v[152:167]
    buffer_load_dwordx4 v19, s[36:39], s82 offen offset:1024 lds
    v_mul_f32 v217, v225, v217
    v_cvt_pk_bf16_f32 v236, v216, v217
    v_mul_f32 v218, v225, v218
    v_mfma_f32_32x32x16_bf16 v[152:167], a[220:223], a[56:59], v[152:167]
    v_mul_f32 v219, v225, v219
    v_cvt_pk_bf16_f32 v237, v218, v219
    v_mul_f32 v220, v225, v220
    v_mul_f32 v221, v225, v221
    s_waitcnt vmcnt(13)
    v_mfma_f32_32x32x16_bf16 v[152:167], a[228:231], a[128:131], v[152:167]
    buffer_load_dwordx4 v20, s[36:39], s82 offen offset:2048 lds
    v_cvt_pk_bf16_f32 v238, v220, v221
    v_mul_f32 v222, v225, v222
    v_mul_f32 v223, v225, v223
    v_mfma_f32_32x32x16_bf16 v[152:167], a[236:239], a[136:139], v[152:167]
    v_cvt_pk_bf16_f32 v239, v222, v223
    v_lshl_add_u32 v132, s60, 2, v1
    v_xor_b32 v133, 16384, v132
    v_xor_b32 v134, 32768, v132
    v_mfma_f32_32x32x16_bf16 v[152:167], a[244:247], v[54:57], v[152:167]
    buffer_store_dwordx4 v[236:239], v1, s[20:23], s98 offen offset:1024 sc1
    buffer_load_dwordx4 v21, s[36:39], s82 offen offset:3072 lds
    v_xor_b32 v135, 49152, v132
    v_lshrrev_b32 v129, 5, v0
    s_waitcnt vmcnt(10)
    v_mfma_f32_32x32x16_bf16 v[152:167], a[252:255], v[62:65], v[152:167]
    v_lshlrev_b32 v129, 3, v129
    v_and_b32 v128, 0x1f0, v1
    s_lshr_b32 s100, s52, 1
    s_lshl1_add_u32 s100, s80, s100
    v_mfma_f32_32x32x16_bf16 v[152:167], a[148:151], v[70:73], v[152:167]
    s_bfe_u32 s58, s61, 262160
    s_lshl_b32 s58, s58, 11
    s_add_u32 s57, s58, s84
    s_add_u32 s58, s58, s85
    buffer_load_dwordx4 v[248:251], v1, s[20:23], s57 offen offset:0 sc1
    v_mfma_f32_32x32x16_bf16 v[152:167], a[156:159], v[78:81], v[152:167]
    s_barrier
    s_lshl_b32 s99, s100, 9
    s_add_u32 s99, s99, 16777224
    s_lshl_b32 s100, s100, 15
    s_add_u32 s100, s100, s88
    v_mfma_f32_32x32x16_bf16 v[168:183], a[160:163], a[4:7], 0
    buffer_load_dwordx4 v[252:255], v1, s[20:23], s58 offen offset:0 sc1
    v_and_b32 v98, 31, v0
    v_lshlrev_b32 v98, 10, v98
    v_lshl_add_u32 v98, v129, 1, v98
    v_mfma_f32_32x32x16_bf16 v[168:183], a[168:171], a[12:15], v[168:183]
    s_nop 0
    ds_write_b128 v133, v[152:155] offset:0
    s_lshl3_add_u32 s96, s80, s81
    s_lshl2_add_u32 s96, s96, s52
    s_xor_b32 s97, s96, 128
    v_mfma_f32_32x32x16_bf16 v[168:183], a[176:179], a[20:23], v[168:183]
    buffer_load_dwordx4 v[10:13], v1, s[20:23], s57 offen offset:1024 sc1
    ds_write_b128 v133, v[156:159] offset:1024
    s_lshl_b32 s101, s97, 7
    s_add_u32 s101, s101, 18088032
    v_mfma_f32_32x32x16_bf16 v[168:183], a[184:187], a[28:31], v[168:183]
    ds_write_b128 v133, v[160:163] offset:2048
    s_lshl_b32 s96, s96, 12
    s_add_u32 s96, s96, 20971520
    s_lshl_b32 s97, s97, 12
    v_mfma_f32_32x32x16_bf16 v[168:183], a[192:195], a[36:39], v[168:183]
    buffer_load_dwordx4 v[14:17], v1, s[20:23], s58 offen offset:1024 sc1
    ds_write_b128 v133, v[164:167] offset:3072
    s_add_u32 s97, s97, 20971520
    v_mfma_f32_32x32x16_bf16 v[168:183], a[200:203], a[44:47], v[168:183]
    v_mfma_f32_32x32x16_bf16 v[168:183], a[208:211], a[52:55], v[168:183]
    buffer_load_dwordx4 v[22:25], v1, s[20:23], s57 offen offset:2048 sc1
    v_mfma_f32_32x32x16_bf16 v[168:183], a[216:219], a[60:63], v[168:183]
    v_mfma_f32_32x32x16_bf16 v[168:183], a[224:227], a[132:135], v[168:183]
    buffer_load_dwordx4 v[26:29], v1, s[20:23], s58 offen offset:2048 sc1
    v_mfma_f32_32x32x16_bf16 v[168:183], a[232:235], a[140:143], v[168:183]
    v_mfma_f32_32x32x16_bf16 v[168:183], a[240:243], v[58:61], v[168:183]
    buffer_load_dwordx4 v[30:33], v1, s[20:23], s57 offen offset:3072 sc1
    v_mfma_f32_32x32x16_bf16 v[168:183], a[248:251], v[66:69], v[168:183]
    v_mfma_f32_32x32x16_bf16 v[168:183], a[144:147], v[74:77], v[168:183]
    buffer_load_dwordx4 v[34:37], v1, s[20:23], s58 offen offset:3072 sc1
    v_mfma_f32_32x32x16_bf16 v[168:183], a[152:155], v[82:85], v[168:183]
    v_mfma_f32_32x32x16_bf16 v[184:199], a[164:167], a[4:7], 0
    s_waitcnt vmcnt(9)
    s_mov_b64 exec, 0xff
    buffer_store_dword v109, v107, s[20:23], s78 offen offset:64 sc1
    s_mov_b64 exec, -1
    v_mfma_f32_32x32x16_bf16 v[184:199], a[172:175], a[12:15], v[184:199]
    buffer_load_dwordx2 v[2:3], v129, s[40:43], s88 offen offset:0
    s_bfe_u32 s58, s61, 262168
    s_lshl_b32 s58, s58, 11
    s_add_u32 s57, s58, s84
    s_add_u32 s58, s58, s85
    buffer_load_dwordx4 v[38:41], v1, s[20:23], s57 offen offset:0 sc1
    v_mfma_f32_32x32x16_bf16 v[184:199], a[180:183], a[20:23], v[184:199]
    ds_write_b128 v134, v[168:171] offset:4096
    v_mfma_f32_32x32x16_bf16 v[184:199], a[188:191], a[28:31], v[184:199]
    buffer_load_dwordx2 v[4:5], v129, s[40:43], s88 offen offset:16
    buffer_load_dwordx4 v[42:45], v1, s[20:23], s58 offen offset:0 sc1
    ds_write_b128 v134, v[172:175] offset:5120
    v_mfma_f32_32x32x16_bf16 v[184:199], a[196:199], a[36:39], v[184:199]
    ds_write_b128 v134, v[176:179] offset:6144
    v_mfma_f32_32x32x16_bf16 v[184:199], a[204:207], a[44:47], v[184:199]
    buffer_load_dwordx2 v[6:7], v129, s[40:43], s88 offen offset:32
    buffer_load_dwordx4 v[46:49], v1, s[20:23], s57 offen offset:1024 sc1
    ds_write_b128 v134, v[180:183] offset:7168
    v_mfma_f32_32x32x16_bf16 v[184:199], a[212:215], a[52:55], v[184:199]
    v_mfma_f32_32x32x16_bf16 v[184:199], a[220:223], a[60:63], v[184:199]
    buffer_load_dwordx2 v[8:9], v129, s[40:43], s88 offen offset:48
    buffer_load_dwordx4 v[50:53], v1, s[20:23], s58 offen offset:1024 sc1
    v_mfma_f32_32x32x16_bf16 v[184:199], a[228:231], a[132:135], v[184:199]
    v_mfma_f32_32x32x16_bf16 v[184:199], a[236:239], a[140:143], v[184:199]
    buffer_load_dwordx2 v[96:97], v128, s[20:23], s99 offen sc1
    v_mfma_f32_32x32x16_bf16 v[184:199], a[244:247], v[58:61], v[184:199]
    v_mfma_f32_32x32x16_bf16 v[184:199], a[252:255], v[66:69], v[184:199]
    v_mfma_f32_32x32x16_bf16 v[184:199], a[148:151], v[74:77], v[184:199]
    v_mfma_f32_32x32x16_bf16 v[184:199], a[156:159], v[82:85], v[184:199]
    v_mfma_f32_32x32x16_bf16 v[136:151], a[160:163], a[0:3], 0
    s_nop 10
    ds_write_b128 v135, v[184:187] offset:8192
    v_mfma_f32_32x32x16_bf16 v[136:151], a[168:171], a[8:11], v[136:151]
    ds_write_b128 v135, v[188:191] offset:9216
    v_mfma_f32_32x32x16_bf16 v[136:151], a[176:179], a[16:19], v[136:151]
    ds_write_b128 v135, v[192:195] offset:10240
    v_mfma_f32_32x32x16_bf16 v[136:151], a[184:187], a[24:27], v[136:151]
    ds_write_b128 v135, v[196:199] offset:11264
    v_mfma_f32_32x32x16_bf16 v[136:151], a[192:195], a[32:35], v[136:151]
    v_mfma_f32_32x32x16_bf16 v[136:151], a[200:203], a[40:43], v[136:151]
    v_mfma_f32_32x32x16_bf16 v[136:151], a[208:211], a[48:51], v[136:151]
    s_waitcnt lgkmcnt(0)
    s_barrier
    ds_read_b128 v[152:155], v132 offset:0
    ds_read_b128 v[168:171], v132 offset:4096
    ds_read_b128 v[184:187], v132 offset:8192
    v_mfma_f32_32x32x16_bf16 v[136:151], a[216:219], a[56:59], v[136:151]
    ds_read_b128 v[156:159], v132 offset:1024
    ds_read_b128 v[172:175], v132 offset:5120
    ds_read_b128 v[188:191], v132 offset:9216
    v_mfma_f32_32x32x16_bf16 v[136:151], a[224:227], a[128:131], v[136:151]
    ds_read_b128 v[160:163], v132 offset:2048
    ds_read_b128 v[176:179], v132 offset:6144
    ds_read_b128 v[192:195], v132 offset:10240
    s_waitcnt lgkmcnt(7)
    v_add_f32 v152, v152, v168
    v_mfma_f32_32x32x16_bf16 v[136:151], a[232:235], a[136:139], v[136:151]
    ds_read_b128 v[164:167], v132 offset:3072
    ds_read_b128 v[180:183], v132 offset:7168
    ds_read_b128 v[196:199], v132 offset:11264
    v_add_f32 v153, v153, v169
    v_mfma_f32_32x32x16_bf16 v[136:151], a[240:243], v[54:57], v[136:151]
    v_add_f32 v154, v154, v170
    v_add_f32 v155, v155, v171
    s_waitcnt lgkmcnt(9)
    v_add_f32 v152, v152, v184
    v_add_f32 v153, v153, v185
    v_mfma_f32_32x32x16_bf16 v[136:151], a[248:251], v[62:65], v[136:151]
    v_add_f32 v154, v154, v186
    v_add_f32 v155, v155, v187
    s_waitcnt lgkmcnt(7)
    v_add_f32 v156, v156, v172
    v_add_f32 v157, v157, v173
    v_mfma_f32_32x32x16_bf16 v[136:151], a[144:147], v[70:73], v[136:151]
    v_add_f32 v158, v158, v174
    v_add_f32 v159, v159, v175
    s_waitcnt lgkmcnt(6)
    v_add_f32 v156, v156, v188
    v_add_f32 v157, v157, v189
    v_mfma_f32_32x32x16_bf16 v[136:151], a[152:155], v[78:81], v[136:151]
    v_add_f32 v158, v158, v190
    v_add_f32 v159, v159, v191
    s_waitcnt lgkmcnt(4)
    v_add_f32 v160, v160, v176
    v_add_f32 v161, v161, v177
    v_mfma_f32_32x32x16_bf16 v[200:215], a[160:163], a[64:67], 0
    v_add_f32 v162, v162, v178
    v_add_f32 v163, v163, v179
    s_waitcnt lgkmcnt(3)
    v_add_f32 v160, v160, v192
    v_add_f32 v161, v161, v193
    v_mfma_f32_32x32x16_bf16 v[216:231], a[164:167], a[64:67], 0
    v_add_f32 v162, v162, v194
    v_add_f32 v163, v163, v195
    s_waitcnt lgkmcnt(1)
    v_add_f32 v164, v164, v180
    v_add_f32 v165, v165, v181
    v_mfma_f32_32x32x16_bf16 v[232:247], a[160:163], a[68:71], 0
    v_add_f32 v166, v166, v182
    v_add_f32 v167, v167, v183
    s_waitcnt lgkmcnt(0)
    v_add_f32 v164, v164, v196
    v_add_f32 v165, v165, v197
    v_mfma_f32_32x32x16_bf16 v[112:127], a[164:167], a[68:71], 0
    v_add_f32 v166, v166, v198
    v_add_f32 v167, v167, v199
    v_add_f32 v136, v136, v152
    v_add_f32 v137, v137, v153
    v_mfma_f32_32x32x16_bf16 v[200:215], a[168:171], a[72:75], v[200:215]
    v_add_f32 v138, v138, v154
    v_add_f32 v139, v139, v155
    v_mfma_f32_32x32x16_bf16 v[216:231], a[172:175], a[72:75], v[216:231]
    buffer_store_dwordx4 v[136:139], v1, s[20:23], s97 offen offset:0 sc1
    v_add_f32 v140, v140, v156
    v_add_f32 v141, v141, v157
    v_add_f32 v142, v142, v158
    v_mfma_f32_32x32x16_bf16 v[232:247], a[168:171], a[76:79], v[232:247]
    v_add_f32 v143, v143, v159
    v_mfma_f32_32x32x16_bf16 v[112:127], a[172:175], a[76:79], v[112:127]
    buffer_store_dwordx4 v[140:143], v1, s[20:23], s97 offen offset:1024 sc1
    v_add_f32 v144, v144, v160
    v_add_f32 v145, v145, v161
    v_add_f32 v146, v146, v162
    v_mfma_f32_32x32x16_bf16 v[200:215], a[176:179], a[80:83], v[200:215]
    ds_read_b64_tr_b16 a[160:161], v102 offset:49152
    ds_read_b64_tr_b16 a[162:163], v102 offset:50176
    ds_read_b64_tr_b16 a[164:165], v103 offset:49152
    v_mfma_f32_32x32x16_bf16 v[216:231], a[180:183], a[80:83], v[216:231]
    ds_read_b64_tr_b16 a[166:167], v103 offset:50176
    ds_read_b64_tr_b16 a[168:169], v102 offset:51200
    ds_read_b64_tr_b16 a[170:171], v102 offset:52224
    v_add_f32 v147, v147, v163
    v_mfma_f32_32x32x16_bf16 v[232:247], a[176:179], a[84:87], v[232:247]
    buffer_store_dwordx4 v[144:147], v1, s[20:23], s97 offen offset:2048 sc1
    ds_read_b64_tr_b16 a[172:173], v103 offset:51200
    ds_read_b64_tr_b16 a[174:175], v103 offset:52224
    v_add_f32 v148, v148, v164
    v_mfma_f32_32x32x16_bf16 v[112:127], a[180:183], a[84:87], v[112:127]
    v_add_f32 v149, v149, v165
    v_add_f32 v150, v150, v166
    v_add_f32 v151, v151, v167
    v_mfma_f32_32x32x16_bf16 v[200:215], a[184:187], a[88:91], v[200:215]
    s_load_dwordx8 s[8:15], s[26:27], 64 glc
    v_mfma_f32_32x32x16_bf16 v[216:231], a[188:191], a[88:91], v[216:231]
    buffer_store_dwordx4 v[148:151], v1, s[20:23], s97 offen offset:3072 sc1
    v_mfma_f32_32x32x16_bf16 v[232:247], a[184:187], a[92:95], v[232:247]
    v_mfma_f32_32x32x16_bf16 v[112:127], a[188:191], a[92:95], v[112:127]
    v_mfma_f32_32x32x16_bf16 v[200:215], a[192:195], a[96:99], v[200:215]
    ds_read_b64_tr_b16 a[176:177], v104 offset:0
    ds_read_b64_tr_b16 a[178:179], v104 offset:1024
    ds_read_b64_tr_b16 a[180:181], v105 offset:0
    v_mfma_f32_32x32x16_bf16 v[216:231], a[196:199], a[96:99], v[216:231]
    ds_read_b64_tr_b16 a[182:183], v105 offset:1024
    ds_read_b64_tr_b16 a[184:185], v104 offset:2048
    ds_read_b64_tr_b16 a[186:187], v104 offset:3072
    s_waitcnt vmcnt(4)
    v_cmp_ne_u32 vcc, v109, v97
    s_nop 0
    s_cbranch_vccnz L_G_S
L_G_R:
    v_add_f32 v96, 1.0, v96
    v_mfma_f32_32x32x16_bf16 v[232:247], a[192:195], a[100:103], v[232:247]
    ds_read_b64_tr_b16 a[188:189], v105 offset:2048
    ds_read_b64_tr_b16 a[190:191], v105 offset:3072
    v_rcp_f32 v96, v96
    v_mfma_f32_32x32x16_bf16 v[112:127], a[196:199], a[100:103], v[112:127]
    v_lshlrev_b32 v152, 16, v2
    v_and_b32 v153, 0xffff0000, v2
    v_lshlrev_b32 v154, 16, v3
    v_and_b32 v155, 0xffff0000, v3
    v_mfma_f32_32x32x16_bf16 v[200:215], a[200:203], a[104:107], v[200:215]
    v_lshlrev_b32 v156, 16, v4
    v_and_b32 v157, 0xffff0000, v4
    v_lshlrev_b32 v158, 16, v5
    v_and_b32 v159, 0xffff0000, v5
    v_mfma_f32_32x32x16_bf16 v[216:231], a[204:207], a[104:107], v[216:231]
    v_lshlrev_b32 v160, 16, v6
    v_and_b32 v161, 0xffff0000, v6
    v_lshlrev_b32 v162, 16, v7
    v_and_b32 v163, 0xffff0000, v7
    v_mfma_f32_32x32x16_bf16 v[232:247], a[200:203], a[108:111], v[232:247]
    v_lshlrev_b32 v164, 16, v8
    v_and_b32 v165, 0xffff0000, v8
    v_lshlrev_b32 v166, 16, v9
    v_and_b32 v167, 0xffff0000, v9
    v_mfma_f32_32x32x16_bf16 v[112:127], a[204:207], a[108:111], v[112:127]
    v_mul_f32 v152, v96, v152
    v_mul_f32 v153, v96, v153
    v_mul_f32 v154, v96, v154
    v_mul_f32 v155, v96, v155
    v_mfma_f32_32x32x16_bf16 v[200:215], a[208:211], a[112:115], v[200:215]
    v_mul_f32 v156, v96, v156
    v_mul_f32 v157, v96, v157
    v_mul_f32 v158, v96, v158
    v_mul_f32 v159, v96, v159
    v_mfma_f32_32x32x16_bf16 v[216:231], a[212:215], a[112:115], v[216:231]
    v_mul_f32 v160, v96, v160
    v_mul_f32 v161, v96, v161
    v_mul_f32 v162, v96, v162
    v_mul_f32 v163, v96, v163
    v_mfma_f32_32x32x16_bf16 v[232:247], a[208:211], a[116:119], v[232:247]
    v_mul_f32 v164, v96, v164
    v_mul_f32 v165, v96, v165
    v_mul_f32 v166, v96, v166
    v_mul_f32 v167, v96, v167
    v_mfma_f32_32x32x16_bf16 v[112:127], a[212:215], a[116:119], v[112:127]
    v_mfma_f32_32x32x16_bf16 v[200:215], a[216:219], a[120:123], v[200:215]
    s_waitcnt lgkmcnt(0)
    s_cmp_eq_u64 s[8:9], s[28:29]
    s_cbranch_scc0 L_PO_S
    s_cmp_eq_u64 s[10:11], s[28:29]
    s_cbranch_scc0 L_PO_S
    s_cmp_eq_u64 s[12:13], s[28:29]
    s_cbranch_scc0 L_PO_S
    s_cmp_eq_u64 s[14:15], s[28:29]
    s_cbranch_scc0 L_PO_S
L_PO_R:
    s_barrier
    s_sub_u32 s58, s85, s84
    s_mov_b32 s57, s86
    s_add_u32 s58, s58, s86
    s_add_u32 s84, s57, 4096
    s_add_u32 s85, s58, 4096
    buffer_load_dwordx4 a[0:3], v1, s[20:23], s57 offen offset:0 sc1
    v_mfma_f32_32x32x16_bf16 v[216:231], a[220:223], a[120:123], v[216:231]
    buffer_load_dwordx4 a[8:11], v1, s[20:23], s57 offen offset:1024 sc1
    v_mfma_f32_32x32x16_bf16 v[232:247], a[216:219], a[124:127], v[232:247]
    v_mfma_f32_32x32x16_bf16 v[112:127], a[220:223], a[124:127], v[112:127]
    buffer_load_dwordx4 a[16:19], v1, s[20:23], s57 offen offset:2048 sc1
    v_mfma_f32_32x32x16_bf16 v[200:215], a[224:227], v[248:251], v[200:215]
    s_waitcnt vmcnt(3)
    s_mov_b64 exec, 1
    buffer_store_dword v109, v110, s[20:23], s101 offen sc1
    buffer_store_dword v109, v110, s[20:23], s101 offen offset:4 sc1
    s_mov_b64 exec, -1
    v_mfma_f32_32x32x16_bf16 v[216:231], a[228:231], v[248:251], v[216:231]
    buffer_load_dwordx4 a[24:27], v1, s[20:23], s57 offen offset:3072 sc1
    ds_read_b64_tr_b16 a[192:193], v104 offset:16384
    ds_read_b64_tr_b16 a[194:195], v104 offset:17408
    v_mfma_f32_32x32x16_bf16 v[232:247], a[224:227], v[252:255], v[232:247]
    ds_read_b64_tr_b16 a[196:197], v105 offset:16384
    ds_read_b64_tr_b16 a[198:199], v105 offset:17408
    ds_read_b64_tr_b16 a[200:201], v104 offset:18432
    v_mfma_f32_32x32x16_bf16 v[112:127], a[228:231], v[252:255], v[112:127]
    buffer_load_dwordx4 a[32:35], v1, s[20:23], s84 offen offset:0 sc1
    ds_read_b64_tr_b16 a[202:203], v104 offset:19456
    ds_read_b64_tr_b16 a[204:205], v105 offset:18432
    ds_read_b64_tr_b16 a[206:207], v105 offset:19456
    v_mfma_f32_32x32x16_bf16 v[200:215], a[232:235], v[10:13], v[200:215]
    buffer_load_dwordx4 a[40:43], v1, s[20:23], s84 offen offset:1024 sc1
    ds_read_b64_tr_b16 a[208:209], v102 offset:0
    ds_read_b64_tr_b16 a[210:211], v102 offset:1024
    v_mfma_f32_32x32x16_bf16 v[216:231], a[236:239], v[10:13], v[216:231]
    ds_read_b64_tr_b16 a[212:213], v103 offset:0
    ds_read_b64_tr_b16 a[214:215], v103 offset:1024
    ds_read_b64_tr_b16 a[216:217], v102 offset:2048
    v_mfma_f32_32x32x16_bf16 v[232:247], a[232:235], v[14:17], v[232:247]
    buffer_load_dwordx4 a[48:51], v1, s[20:23], s84 offen offset:2048 sc1
    ds_read_b64_tr_b16 a[218:219], v102 offset:3072
    ds_read_b64_tr_b16 a[220:221], v103 offset:2048
    ds_read_b64_tr_b16 a[222:223], v103 offset:3072
    v_mfma_f32_32x32x16_bf16 v[112:127], a[236:239], v[14:17], v[112:127]
    v_mfma_f32_32x32x16_bf16 v[200:215], a[240:243], v[22:25], v[200:215]
    buffer_load_dwordx4 a[56:59], v1, s[20:23], s84 offen offset:3072 sc1
    v_mfma_f32_32x32x16_bf16 v[216:231], a[244:247], v[22:25], v[216:231]
    v_mfma_f32_32x32x16_bf16 v[232:247], a[240:243], v[26:29], v[232:247]
    buffer_load_dwordx4 a[4:7], v1, s[20:23], s58 offen offset:0 sc1
    v_mfma_f32_32x32x16_bf16 v[112:127], a[244:247], v[26:29], v[112:127]
    buffer_load_dwordx4 a[12:15], v1, s[20:23], s58 offen offset:1024 sc1
    v_mfma_f32_32x32x16_bf16 v[200:215], a[248:251], v[30:33], v[200:215]
    v_mfma_f32_32x32x16_bf16 v[216:231], a[252:255], v[30:33], v[216:231]
    buffer_load_dwordx4 a[20:23], v1, s[20:23], s58 offen offset:2048 sc1
    v_mfma_f32_32x32x16_bf16 v[232:247], a[248:251], v[34:37], v[232:247]
    v_mfma_f32_32x32x16_bf16 v[112:127], a[252:255], v[34:37], v[112:127]
    buffer_load_dwordx4 a[28:31], v1, s[20:23], s58 offen offset:3072 sc1
    s_waitcnt lgkmcnt(0)
    v_mfma_f32_32x32x16_bf16 v[200:215], a[144:147], v[38:41], v[200:215]
    s_load_dwordx8 s[8:15], s[26:27], 96 glc
    v_mfma_f32_32x32x16_bf16 v[216:231], a[148:151], v[38:41], v[216:231]
    buffer_load_dwordx4 a[36:39], v1, s[20:23], s85 offen offset:0 sc1
    v_mfma_f32_32x32x16_bf16 v[232:247], a[144:147], v[42:45], v[232:247]
    buffer_load_dwordx4 a[44:47], v1, s[20:23], s85 offen offset:1024 sc1
    v_mfma_f32_32x32x16_bf16 v[112:127], a[148:151], v[42:45], v[112:127]
    v_mfma_f32_32x32x16_bf16 v[200:215], a[152:155], v[46:49], v[200:215]
    buffer_load_dwordx4 a[52:55], v1, s[20:23], s85 offen offset:2048 sc1
    v_mfma_f32_32x32x16_bf16 v[216:231], a[156:159], v[46:49], v[216:231]
    v_mfma_f32_32x32x16_bf16 v[232:247], a[152:155], v[50:53], v[232:247]
    buffer_load_dwordx4 a[60:63], v1, s[20:23], s85 offen offset:3072 sc1
    v_mfma_f32_32x32x16_bf16 v[112:127], a[156:159], v[50:53], v[112:127]
    s_waitcnt vmcnt(17)
    v_mfma_f32_32x32x16_bf16 v[216:231], a[164:167], a[0:3], v[216:231]
    s_waitcnt vmcnt(16)
    v_mfma_f32_32x32x16_bf16 v[216:231], a[172:175], a[8:11], v[216:231]
    s_waitcnt vmcnt(15)
    v_mfma_f32_32x32x16_bf16 v[216:231], a[180:183], a[16:19], v[216:231]
    s_waitcnt vmcnt(12)
    v_mfma_f32_32x32x16_bf16 v[216:231], a[188:191], a[24:27], v[216:231]
    s_waitcnt vmcnt(11)
    v_mfma_f32_32x32x16_bf16 v[216:231], a[196:199], a[32:35], v[216:231]
    s_waitcnt lgkmcnt(0)
    s_cmp_eq_u64 s[8:9], s[28:29]
    s_cbranch_scc0 L_PP_S
L_PP_R:
    buffer_load_dwordx4 v[184:187], v1, s[20:23], s96 offen offset:0 sc1
    s_waitcnt vmcnt(11)
    v_mfma_f32_32x32x16_bf16 v[216:231], a[204:207], a[40:43], v[216:231]
    buffer_load_dwordx4 v[188:191], v1, s[20:23], s96 offen offset:1024 sc1
    s_waitcnt vmcnt(11)
    v_mfma_f32_32x32x16_bf16 v[216:231], a[212:215], a[48:51], v[216:231]
    s_waitcnt vmcnt(10)
    v_mfma_f32_32x32x16_bf16 v[216:231], a[220:223], a[56:59], v[216:231]
    buffer_load_dwordx4 v[192:195], v1, s[20:23], s96 offen offset:2048 sc1
    s_waitcnt vmcnt(10)
    v_mfma_f32_32x32x16_bf16 v[232:247], a[160:163], a[4:7], v[232:247]
    s_waitcnt vmcnt(9)
    v_mfma_f32_32x32x16_bf16 v[232:247], a[168:171], a[12:15], v[232:247]
    buffer_load_dwordx4 v[196:199], v1, s[20:23], s96 offen offset:3072 sc1
    s_nop 5
    ds_write_b128 v133, v[216:219] offset:0
    s_waitcnt vmcnt(9)
    v_mfma_f32_32x32x16_bf16 v[232:247], a[176:179], a[20:23], v[232:247]
    ds_write_b128 v133, v[220:223] offset:1024
    s_waitcnt vmcnt(8)
    v_mfma_f32_32x32x16_bf16 v[232:247], a[184:187], a[28:31], v[232:247]
    ds_write_b128 v133, v[224:227] offset:2048
    s_waitcnt vmcnt(7)
    v_mfma_f32_32x32x16_bf16 v[232:247], a[192:195], a[36:39], v[232:247]
    ds_write_b128 v133, v[228:231] offset:3072
    s_waitcnt vmcnt(6)
    v_mfma_f32_32x32x16_bf16 v[232:247], a[200:203], a[44:47], v[232:247]
    s_waitcnt vmcnt(5)
    v_mfma_f32_32x32x16_bf16 v[232:247], a[208:211], a[52:55], v[232:247]
    s_waitcnt vmcnt(4)
    v_mfma_f32_32x32x16_bf16 v[232:247], a[216:219], a[60:63], v[232:247]
    v_mfma_f32_32x32x16_bf16 v[112:127], a[164:167], a[4:7], v[112:127]
    v_mfma_f32_32x32x16_bf16 v[112:127], a[172:175], a[12:15], v[112:127]
    s_waitcnt lgkmcnt(0)
    s_barrier
    ds_read_b128 v[38:41], v132 offset:0
    ds_read_b128 v[42:45], v132 offset:1024
    ds_read_b128 v[46:49], v132 offset:2048
    ds_read_b128 v[50:53], v132 offset:3072
    v_mfma_f32_32x32x16_bf16 v[112:127], a[180:183], a[20:23], v[112:127]
    s_nop 2
    ds_write_b128 v134, v[232:235] offset:4096
    v_mfma_f32_32x32x16_bf16 v[112:127], a[188:191], a[28:31], v[112:127]
    ds_write_b128 v134, v[236:239] offset:5120
    s_waitcnt lgkmcnt(5)
    v_add_f32 v152, v152, v38
    v_add_f32 v153, v153, v39
    v_add_f32 v154, v154, v40
    v_add_f32 v155, v155, v41
    v_mfma_f32_32x32x16_bf16 v[112:127], a[196:199], a[36:39], v[112:127]
    ds_write_b128 v134, v[240:243] offset:6144
    s_waitcnt lgkmcnt(5)
    v_add_f32 v156, v156, v42
    v_add_f32 v157, v157, v43
    v_add_f32 v158, v158, v44
    v_add_f32 v159, v159, v45
    v_mfma_f32_32x32x16_bf16 v[112:127], a[204:207], a[44:47], v[112:127]
    ds_write_b128 v134, v[244:247] offset:7168
    s_waitcnt lgkmcnt(5)
    v_add_f32 v160, v160, v46
    v_add_f32 v161, v161, v47
    v_add_f32 v162, v162, v48
    v_add_f32 v163, v163, v49
    v_mfma_f32_32x32x16_bf16 v[112:127], a[212:215], a[52:55], v[112:127]
    s_waitcnt lgkmcnt(4)
    v_add_f32 v164, v164, v50
    v_add_f32 v165, v165, v51
    v_add_f32 v166, v166, v52
    v_add_f32 v167, v167, v53
    v_mfma_f32_32x32x16_bf16 v[112:127], a[220:223], a[60:63], v[112:127]
    v_mfma_f32_32x32x16_bf16 v[200:215], a[160:163], a[0:3], v[200:215]
    v_mfma_f32_32x32x16_bf16 v[200:215], a[168:171], a[8:11], v[200:215]
    s_waitcnt lgkmcnt(0)
    s_barrier
    ds_read_b128 v[54:57], v132 offset:4096
    ds_read_b128 v[58:61], v132 offset:5120
    ds_read_b128 v[62:65], v132 offset:6144
    ds_read_b128 v[66:69], v132 offset:7168
    v_mfma_f32_32x32x16_bf16 v[200:215], a[176:179], a[16:19], v[200:215]
    s_nop 2
    ds_write_b128 v135, v[112:115] offset:8192
    v_mfma_f32_32x32x16_bf16 v[200:215], a[184:187], a[24:27], v[200:215]
    ds_write_b128 v135, v[116:119] offset:9216
    s_waitcnt lgkmcnt(5)
    v_add_f32 v152, v152, v54
    v_add_f32 v153, v153, v55
    v_add_f32 v154, v154, v56
    v_add_f32 v155, v155, v57
    v_mfma_f32_32x32x16_bf16 v[200:215], a[192:195], a[32:35], v[200:215]
    ds_write_b128 v135, v[120:123] offset:10240
    s_waitcnt lgkmcnt(5)
    v_add_f32 v156, v156, v58
    v_add_f32 v157, v157, v59
    v_add_f32 v158, v158, v60
    v_add_f32 v159, v159, v61
    v_mfma_f32_32x32x16_bf16 v[200:215], a[200:203], a[40:43], v[200:215]
    ds_write_b128 v135, v[124:127] offset:11264
    s_waitcnt lgkmcnt(5)
    v_add_f32 v160, v160, v62
    v_add_f32 v161, v161, v63
    v_add_f32 v162, v162, v64
    v_add_f32 v163, v163, v65
    v_mfma_f32_32x32x16_bf16 v[200:215], a[208:211], a[48:51], v[200:215]
    s_waitcnt lgkmcnt(4)
    v_add_f32 v164, v164, v66
    v_add_f32 v165, v165, v67
    v_add_f32 v166, v166, v68
    v_add_f32 v167, v167, v69
    v_mfma_f32_32x32x16_bf16 v[200:215], a[216:219], a[56:59], v[200:215]
    s_waitcnt lgkmcnt(0)
    s_barrier
    ds_read_b128 v[70:73], v132 offset:8192
    ds_read_b128 v[74:77], v132 offset:9216
    ds_read_b128 v[78:81], v132 offset:10240
    ds_read_b128 v[82:85], v132 offset:11264
    s_nop 5
    v_pk_add_f32 v[200:201], v[200:201], v[152:153]
    v_pk_add_f32 v[202:203], v[202:203], v[154:155]
    v_pk_add_f32 v[204:205], v[204:205], v[156:157]
    v_pk_add_f32 v[206:207], v[206:207], v[158:159]
    v_pk_add_f32 v[208:209], v[208:209], v[160:161]
    v_pk_add_f32 v[210:211], v[210:211], v[162:163]
    v_pk_add_f32 v[212:213], v[212:213], v[164:165]
    v_pk_add_f32 v[214:215], v[214:215], v[166:167]
    s_waitcnt vmcnt(3)
    v_pk_add_f32 v[200:201], v[200:201], v[184:185]
    v_pk_add_f32 v[202:203], v[202:203], v[186:187]
    s_waitcnt vmcnt(2)
    v_pk_add_f32 v[204:205], v[204:205], v[188:189]
    v_pk_add_f32 v[206:207], v[206:207], v[190:191]
    s_waitcnt vmcnt(1)
    v_pk_add_f32 v[208:209], v[208:209], v[192:193]
    v_pk_add_f32 v[210:211], v[210:211], v[194:195]
    s_waitcnt vmcnt(0)
    v_pk_add_f32 v[212:213], v[212:213], v[196:197]
    v_pk_add_f32 v[214:215], v[214:215], v[198:199]
    s_waitcnt lgkmcnt(3)
    v_pk_add_f32 v[200:201], v[200:201], v[70:71]
    v_pk_add_f32 v[202:203], v[202:203], v[72:73]
    v_cvt_pk_bf16_f32 v22, v200, v201
    v_cvt_pk_bf16_f32 v23, v202, v203
    s_waitcnt lgkmcnt(2)
    v_pk_add_f32 v[204:205], v[204:205], v[74:75]
    v_pk_add_f32 v[206:207], v[206:207], v[76:77]
    v_cvt_pk_bf16_f32 v24, v204, v205
    v_cvt_pk_bf16_f32 v25, v206, v207
    s_nop 0
    v_permlane32_swap_b32 v22, v24
    v_permlane32_swap_b32 v23, v25
    buffer_store_dwordx4 v[22:25], v98, s[44:47], s100 offen offset:0
    s_waitcnt lgkmcnt(1)
    v_pk_add_f32 v[208:209], v[208:209], v[78:79]
    v_pk_add_f32 v[210:211], v[210:211], v[80:81]
    v_cvt_pk_bf16_f32 v26, v208, v209
    v_cvt_pk_bf16_f32 v27, v210, v211
    s_waitcnt lgkmcnt(0)
    v_pk_add_f32 v[212:213], v[212:213], v[82:83]
    v_pk_add_f32 v[214:215], v[214:215], v[84:85]
    v_cvt_pk_bf16_f32 v28, v212, v213
    v_cvt_pk_bf16_f32 v29, v214, v215
    s_nop 0
    v_permlane32_swap_b32 v26, v28
    v_permlane32_swap_b32 v27, v29
    buffer_store_dwordx4 v[26:29], v98, s[44:47], s100 offen offset:32
L_END:
    s_endpgm
L_P1X_S:
    s_mov_b32 s89, 0x80000
L_P1X_L:
    s_sub_u32 s89, s89, 1
    s_cmp_eq_u32 s89, 0
    s_cbranch_scc1 L_P1X_R
    s_load_dwordx8 s[8:15], s[24:25], 0 glc
    s_waitcnt lgkmcnt(0)
    s_cmp_lt_u32 s53, 2
    s_cselect_b64 s[12:13], s[28:29], s[12:13]
    s_cmp_lt_u32 s53, 1
    s_cselect_b64 s[10:11], s[28:29], s[10:11]
    s_cmp_eq_u64 s[8:9], s[28:29]
    s_cbranch_scc0 L_P1X_L
    s_cmp_eq_u64 s[10:11], s[28:29]
    s_cbranch_scc0 L_P1X_L
    s_cmp_eq_u64 s[12:13], s[28:29]
    s_cbranch_scc0 L_P1X_L
    s_branch L_P1X_R
L_P1Y_S:
    s_mov_b32 s89, 0x80000
L_P1Y_L:
    s_sub_u32 s89, s89, 1
    s_cmp_eq_u32 s89, 0
    s_cbranch_scc1 L_P1Y_R
    s_load_dwordx8 s[8:15], s[24:25], 0 glc
    s_waitcnt lgkmcnt(0)
    s_cmp_lt_u32 s53, 2
    s_cselect_b64 s[12:13], s[28:29], s[12:13]
    s_cmp_lt_u32 s53, 1
    s_cselect_b64 s[10:11], s[28:29], s[10:11]
    s_cmp_eq_u64 s[8:9], s[28:29]
    s_cbranch_scc0 L_P1Y_L
    s_cmp_eq_u64 s[10:11], s[28:29]
    s_cbranch_scc0 L_P1Y_L
    s_cmp_eq_u64 s[12:13], s[28:29]
    s_cbranch_scc0 L_P1Y_L
    s_branch L_P1Y_R
L_PQ_S:
    s_mov_b32 s89, 0x80000
L_PQ_L:
    s_sub_u32 s89, s89, 1
    s_cmp_eq_u32 s89, 0
    s_cbranch_scc1 L_PQ_R
    s_load_dwordx8 s[8:15], s[24:25], 0 glc
    s_waitcnt lgkmcnt(0)
    s_cmp_lt_u32 s53, 2
    s_cselect_b64 s[12:13], s[28:29], s[12:13]
    s_cmp_lt_u32 s53, 1
    s_cselect_b64 s[10:11], s[28:29], s[10:11]
    s_cmp_eq_u64 s[14:15], s[28:29]
    s_cbranch_scc0 L_PQ_L
    s_branch L_PQ_R
L_PH_S:
    s_mov_b32 s89, 0x80000
L_PH_L:
    s_sub_u32 s89, s89, 1
    s_cmp_eq_u32 s89, 0
    s_cbranch_scc1 L_PH_R
    s_load_dwordx8 s[8:15], s[26:27], 0 glc
    s_waitcnt lgkmcnt(0)
    s_cmp_eq_u64 s[8:9], s[28:29]
    s_cbranch_scc0 L_PH_L
    s_cmp_eq_u64 s[10:11], s[28:29]
    s_cbranch_scc0 L_PH_L
    s_cmp_eq_u64 s[12:13], s[28:29]
    s_cbranch_scc0 L_PH_L
    s_cmp_eq_u64 s[14:15], s[28:29]
    s_cbranch_scc0 L_PH_L
    s_branch L_PH_R
L_PH2_S:
    s_mov_b32 s89, 0x80000
L_PH2_L:
    s_sub_u32 s89, s89, 1
    s_cmp_eq_u32 s89, 0
    s_cbranch_scc1 L_PH2_R
    s_load_dwordx8 s[8:15], s[26:27], 32 glc
    s_waitcnt lgkmcnt(0)
    s_cmp_eq_u64 s[8:9], s[28:29]
    s_cbranch_scc0 L_PH2_L
    s_cmp_eq_u64 s[10:11], s[28:29]
    s_cbranch_scc0 L_PH2_L
    s_cmp_eq_u64 s[12:13], s[28:29]
    s_cbranch_scc0 L_PH2_L
    s_cmp_eq_u64 s[14:15], s[28:29]
    s_cbranch_scc0 L_PH2_L
    s_branch L_PH2_R
L_PO_S:
    s_mov_b32 s89, 0x80000
L_PO_L:
    s_sub_u32 s89, s89, 1
    s_cmp_eq_u32 s89, 0
    s_cbranch_scc1 L_PO_R
    s_load_dwordx8 s[8:15], s[26:27], 64 glc
    s_waitcnt lgkmcnt(0)
    s_cmp_eq_u64 s[8:9], s[28:29]
    s_cbranch_scc0 L_PO_L
    s_cmp_eq_u64 s[10:11], s[28:29]
    s_cbranch_scc0 L_PO_L
    s_cmp_eq_u64 s[12:13], s[28:29]
    s_cbranch_scc0 L_PO_L
    s_cmp_eq_u64 s[14:15], s[28:29]
    s_cbranch_scc0 L_PO_L
    s_branch L_PO_R
L_PP_S:
    s_mov_b32 s89, 0x80000
L_PP_L:
    s_sub_u32 s89, s89, 1
    s_cmp_eq_u32 s89, 0
    s_cbranch_scc1 L_PP_R
    s_load_dwordx8 s[8:15], s[26:27], 96 glc
    s_waitcnt lgkmcnt(0)
    s_cmp_eq_u64 s[8:9], s[28:29]
    s_cbranch_scc0 L_PP_L
    s_branch L_PP_R
L_EPX_S:
    s_mov_b32 s89, 0x40000
L_EPX_L:
    buffer_load_dword v109, v110, s[48:51], 0 offen sc1
    s_waitcnt vmcnt(0)
    v_cmp_eq_u32 vcc, 0, v109
    s_nop 1
    s_cbranch_vccz L_EPX_R
    s_sub_u32 s89, s89, 1
    s_cmp_lg_u32 s89, 0
    s_cbranch_scc1 L_EPX_L
    s_branch L_EPX_R
L_RCX_S:
    s_mov_b32 s89, 0x40000
L_RCX_L:
    buffer_load_dwordx4 v[74:77], v108, s[20:23], s73 offen sc1
    s_waitcnt vmcnt(0)
    v_cmp_ne_u32 vcc, v109, v77
    s_nop 1
    s_cbranch_vccz L_RCX_R
    s_sub_u32 s89, s89, 1
    s_cmp_lg_u32 s89, 0
    s_cbranch_scc1 L_RCX_L
    s_branch L_RCX_R
L_EPY_S:
    s_mov_b32 s89, 0x40000
L_EPY_L:
    buffer_load_dword v109, v110, s[48:51], 0 offen sc1
    s_waitcnt vmcnt(0)
    v_cmp_eq_u32 vcc, 0, v109
    s_nop 1
    s_cbranch_vccz L_EPY_R
    s_sub_u32 s89, s89, 1
    s_cmp_lg_u32 s89, 0
    s_cbranch_scc1 L_EPY_L
    s_branch L_EPY_R
L_RCY_S:
    s_mov_b32 s89, 0x40000
L_RCY_L:
    buffer_load_dwordx4 v[74:77], v108, s[20:23], s73 offen sc1
    s_waitcnt vmcnt(0)
    v_cmp_ne_u32 vcc, v109, v77
    s_nop 1
    s_cbranch_vccz L_RCY_R
    s_sub_u32 s89, s89, 1
    s_cmp_lg_u32 s89, 0
    s_cbranch_scc1 L_RCY_L
    s_branch L_RCY_R
L_G_S:
    s_mov_b32 s89, 0x40000
L_G_L:
    buffer_load_dwordx2 v[96:97], v128, s[20:23], s99 offen sc1
    s_waitcnt vmcnt(0)
    v_cmp_ne_u32 vcc, v109, v97
    s_nop 1
    s_cbranch_vccz L_G_R
    s_sub_u32 s89, s89, 1
    s_cmp_lg_u32 s89, 0
    s_cbranch_scc1 L_G_L
    s_branch L_G_R
L_FB:
    s_nop 11
    s_min_u32 s90, s56, 8
    s_sub_u32 s89, 8, s90
    s_mul_i32 s94, s89, 4128
    v_add_u32 v32, s94, v93
    v_add_u32 v33, s94, v94
    v_add_u32 v34, s94, v95
    v_mov_b32 v30, 0xf149f2ca
    v_mov_b32 v31, 0xf149f2ca
L_FBA:
    ds_read_b128 v[22:25], v32 offset:0
    ds_read_b128 v[26:29], v32 offset:1024
    s_waitcnt lgkmcnt(1)
    v_mfma_f32_32x32x16_bf16 v[136:151], v[22:25], v[2:5], 0
    s_waitcnt lgkmcnt(0)
    v_mfma_f32_32x32x16_bf16 v[152:167], v[26:29], v[6:9], 0
    v_mov_b32 v35, 0xf149f2ca
    s_nop 10
    s_cmp_lg_u32 s89, 0
    s_cbranch_scc1 L_FBA_1
    v_bfi_b32 v136, v112, v136, v35
    v_bfi_b32 v137, v113, v137, v35
    v_bfi_b32 v138, v114, v138, v35
    v_bfi_b32 v139, v115, v139, v35
    v_bfi_b32 v140, v116, v140, v35
    v_bfi_b32 v141, v117, v141, v35
    v_bfi_b32 v142, v118, v142, v35
    v_bfi_b32 v143, v119, v143, v35
    v_bfi_b32 v144, v120, v144, v35
    v_bfi_b32 v145, v121, v145, v35
    v_bfi_b32 v146, v122, v146, v35
    v_bfi_b32 v147, v123, v147, v35
    v_bfi_b32 v148, v124, v148, v35
    v_bfi_b32 v149, v125, v149, v35
    v_bfi_b32 v150, v126, v150, v35
    v_bfi_b32 v151, v127, v151, v35
    v_bfi_b32 v152, v112, v152, v35
    v_bfi_b32 v153, v113, v153, v35
    v_bfi_b32 v154, v114, v154, v35
    v_bfi_b32 v155, v115, v155, v35
    v_bfi_b32 v156, v116, v156, v35
    v_bfi_b32 v157, v117, v157, v35
    v_bfi_b32 v158, v118, v158, v35
    v_bfi_b32 v159, v119, v159, v35
    v_bfi_b32 v160, v120, v160, v35
    v_bfi_b32 v161, v121, v161, v35
    v_bfi_b32 v162, v122, v162, v35
    v_bfi_b32 v163, v123, v163, v35
    v_bfi_b32 v164, v124, v164, v35
    v_bfi_b32 v165, v125, v165, v35
    v_bfi_b32 v166, v126, v166, v35
    v_bfi_b32 v167, v127, v167, v35
L_FBA_1:
    s_cmp_lg_u32 s89, 8
    s_cbranch_scc1 L_FBA_2
    v_bfi_b32 v136, v112, v35, v136
    v_bfi_b32 v137, v113, v35, v137
    v_bfi_b32 v138, v114, v35, v138
    v_bfi_b32 v139, v115, v35, v139
    v_bfi_b32 v140, v116, v35, v140
    v_bfi_b32 v141, v117, v35, v141
    v_bfi_b32 v142, v118, v35, v142
    v_bfi_b32 v143, v119, v35, v143
    v_bfi_b32 v144, v120, v35, v144
    v_bfi_b32 v145, v121, v35, v145
    v_bfi_b32 v146, v122, v35, v146
    v_bfi_b32 v147, v123, v35, v147
    v_bfi_b32 v148, v124, v35, v148
    v_bfi_b32 v149, v125, v35, v149
    v_bfi_b32 v150, v126, v35, v150
    v_bfi_b32 v151, v127, v35, v151
    v_bfi_b32 v152, v112, v35, v152
    v_bfi_b32 v153, v113, v35, v153
    v_bfi_b32 v154, v114, v35, v154
    v_bfi_b32 v155, v115, v35, v155
    v_bfi_b32 v156, v116, v35, v156
    v_bfi_b32 v157, v117, v35, v157
    v_bfi_b32 v158, v118, v35, v158
    v_bfi_b32 v159, v119, v35, v159
    v_bfi_b32 v160, v120, v35, v160
    v_bfi_b32 v161, v121, v35, v161
    v_bfi_b32 v162, v122, v35, v162
    v_bfi_b32 v163, v123, v35, v163
    v_bfi_b32 v164, v124, v35, v164
    v_bfi_b32 v165, v125, v35, v165
    v_bfi_b32 v166, v126, v35, v166
    v_bfi_b32 v167, v127, v35, v167
L_FBA_2:
    v_max3_f32 v30, v30, v136, v137
    v_max3_f32 v30, v30, v138, v139
    v_max3_f32 v30, v30, v140, v141
    v_max3_f32 v30, v30, v142, v143
    v_max3_f32 v30, v30, v144, v145
    v_max3_f32 v30, v30, v146, v147
    v_max3_f32 v30, v30, v148, v149
    v_max3_f32 v30, v30, v150, v151
    v_max3_f32 v31, v31, v152, v153
    v_max3_f32 v31, v31, v154, v155
    v_max3_f32 v31, v31, v156, v157
    v_max3_f32 v31, v31, v158, v159
    v_max3_f32 v31, v31, v160, v161
    v_max3_f32 v31, v31, v162, v163
    v_max3_f32 v31, v31, v164, v165
    v_max3_f32 v31, v31, v166, v167
    v_add_u32 v32, 4128, v32
    v_add_u32 v33, 4128, v33
    v_add_u32 v34, 4128, v34
    s_nop 4
    s_add_u32 s89, s89, 1
    s_cmp_le_u32 s89, 8
    s_cbranch_scc1 L_FBA
    v_mov_b32 v35, v30
    s_nop 1
    v_permlane32_swap_b32 v30, v35
    v_max_f32 v30, v30, v35
    v_sub_f32 v168, 0, v30
    v_sub_f32 v169, 0, v30
    v_sub_f32 v170, 0, v30
    v_sub_f32 v171, 0, v30
    v_sub_f32 v172, 0, v30
    v_sub_f32 v173, 0, v30
    v_sub_f32 v174, 0, v30
    v_sub_f32 v175, 0, v30
    v_sub_f32 v176, 0, v30
    v_sub_f32 v177, 0, v30
    v_sub_f32 v178, 0, v30
    v_sub_f32 v179, 0, v30
    v_sub_f32 v180, 0, v30
    v_sub_f32 v181, 0, v30
    v_sub_f32 v182, 0, v30
    v_sub_f32 v183, 0, v30
    v_mov_b32 v35, v31
    s_nop 1
    v_permlane32_swap_b32 v31, v35
    v_max_f32 v31, v31, v35
    v_sub_f32 v184, 0, v31
    v_sub_f32 v185, 0, v31
    v_sub_f32 v186, 0, v31
    v_sub_f32 v187, 0, v31
    v_sub_f32 v188, 0, v31
    v_sub_f32 v189, 0, v31
    v_sub_f32 v190, 0, v31
    v_sub_f32 v191, 0, v31
    v_sub_f32 v192, 0, v31
    v_sub_f32 v193, 0, v31
    v_sub_f32 v194, 0, v31
    v_sub_f32 v195, 0, v31
    v_sub_f32 v196, 0, v31
    v_sub_f32 v197, 0, v31
    v_sub_f32 v198, 0, v31
    v_sub_f32 v199, 0, v31
    v_mov_b32 v200, 0
    v_mov_b32 v201, 0
    v_mov_b32 v202, 0
    v_mov_b32 v203, 0
    v_mov_b32 v204, 0
    v_mov_b32 v205, 0
    v_mov_b32 v206, 0
    v_mov_b32 v207, 0
    v_mov_b32 v208, 0
    v_mov_b32 v209, 0
    v_mov_b32 v210, 0
    v_mov_b32 v211, 0
    v_mov_b32 v212, 0
    v_mov_b32 v213, 0
    v_mov_b32 v214, 0
    v_mov_b32 v215, 0
    v_mov_b32 v216, 0
    v_mov_b32 v217, 0
    v_mov_b32 v218, 0
    v_mov_b32 v219, 0
    v_mov_b32 v220, 0
    v_mov_b32 v221, 0
    v_mov_b32 v222, 0
    v_mov_b32 v223, 0
    v_mov_b32 v224, 0
    v_mov_b32 v225, 0
    v_mov_b32 v226, 0
    v_mov_b32 v227, 0
    v_mov_b32 v228, 0
    v_mov_b32 v229, 0
    v_mov_b32 v230, 0
    v_mov_b32 v231, 0
    s_min_u32 s90, s56, 8
    s_sub_u32 s89, 8, s90
    s_mul_i32 s94, s89, 4128
    v_add_u32 v32, s94, v93
    v_add_u32 v33, s94, v94
    v_add_u32 v34, s94, v95
    s_nop 4
L_FBB:
    ds_read_b128 v[22:25], v32 offset:0
    ds_read_b128 v[26:29], v32 offset:1024
    s_waitcnt lgkmcnt(1)
    v_mfma_f32_32x32x16_bf16 v[136:151], v[22:25], v[2:5], v[168:183]
    s_waitcnt lgkmcnt(0)
    v_mfma_f32_32x32x16_bf16 v[152:167], v[26:29], v[6:9], v[184:199]
    v_mov_b32 v35, 0xf149f2ca
    s_nop 10
    s_cmp_lg_u32 s89, 0
    s_cbranch_scc1 L_FBB_1
    v_bfi_b32 v136, v112, v136, v35
    v_bfi_b32 v137, v113, v137, v35
    v_bfi_b32 v138, v114, v138, v35
    v_bfi_b32 v139, v115, v139, v35
    v_bfi_b32 v140, v116, v140, v35
    v_bfi_b32 v141, v117, v141, v35
    v_bfi_b32 v142, v118, v142, v35
    v_bfi_b32 v143, v119, v143, v35
    v_bfi_b32 v144, v120, v144, v35
    v_bfi_b32 v145, v121, v145, v35
    v_bfi_b32 v146, v122, v146, v35
    v_bfi_b32 v147, v123, v147, v35
    v_bfi_b32 v148, v124, v148, v35
    v_bfi_b32 v149, v125, v149, v35
    v_bfi_b32 v150, v126, v150, v35
    v_bfi_b32 v151, v127, v151, v35
    v_bfi_b32 v152, v112, v152, v35
    v_bfi_b32 v153, v113, v153, v35
    v_bfi_b32 v154, v114, v154, v35
    v_bfi_b32 v155, v115, v155, v35
    v_bfi_b32 v156, v116, v156, v35
    v_bfi_b32 v157, v117, v157, v35
    v_bfi_b32 v158, v118, v158, v35
    v_bfi_b32 v159, v119, v159, v35
    v_bfi_b32 v160, v120, v160, v35
    v_bfi_b32 v161, v121, v161, v35
    v_bfi_b32 v162, v122, v162, v35
    v_bfi_b32 v163, v123, v163, v35
    v_bfi_b32 v164, v124, v164, v35
    v_bfi_b32 v165, v125, v165, v35
    v_bfi_b32 v166, v126, v166, v35
    v_bfi_b32 v167, v127, v167, v35
L_FBB_1:
    s_cmp_lg_u32 s89, 8
    s_cbranch_scc1 L_FBB_2
    v_bfi_b32 v136, v112, v35, v136
    v_bfi_b32 v137, v113, v35, v137
    v_bfi_b32 v138, v114, v35, v138
    v_bfi_b32 v139, v115, v35, v139
    v_bfi_b32 v140, v116, v35, v140
    v_bfi_b32 v141, v117, v35, v141
    v_bfi_b32 v142, v118, v35, v142
    v_bfi_b32 v143, v119, v35, v143
    v_bfi_b32 v144, v120, v35, v144
    v_bfi_b32 v145, v121, v35, v145
    v_bfi_b32 v146, v122, v35, v146
    v_bfi_b32 v147, v123, v35, v147
    v_bfi_b32 v148, v124, v35, v148
    v_bfi_b32 v149, v125, v35, v149
    v_bfi_b32 v150, v126, v35, v150
    v_bfi_b32 v151, v127, v35, v151
    v_bfi_b32 v152, v112, v35, v152
    v_bfi_b32 v153, v113, v35, v153
    v_bfi_b32 v154, v114, v35, v154
    v_bfi_b32 v155, v115, v35, v155
    v_bfi_b32 v156, v116, v35, v156
    v_bfi_b32 v157, v117, v35, v157
    v_bfi_b32 v158, v118, v35, v158
    v_bfi_b32 v159, v119, v35, v159
    v_bfi_b32 v160, v120, v35, v160
    v_bfi_b32 v161, v121, v35, v161
    v_bfi_b32 v162, v122, v35, v162
    v_bfi_b32 v163, v123, v35, v163
    v_bfi_b32 v164, v124, v35, v164
    v_bfi_b32 v165, v125, v35, v165
    v_bfi_b32 v166, v126, v35, v166
    v_bfi_b32 v167, v127, v35, v167
L_FBB_2:
    ds_read_b128 v[38:41], v33 offset:0
    ds_read_b128 v[42:45], v33 offset:1040
    ds_read_b128 v[46:49], v34 offset:0
    ds_read_b128 v[50:53], v34 offset:1040
    v_exp_f32 v136, v136
    v_exp_f32 v137, v137
    v_exp_f32 v138, v138
    v_exp_f32 v139, v139
    v_exp_f32 v140, v140
    v_exp_f32 v141, v141
    v_exp_f32 v142, v142
    v_exp_f32 v143, v143
    v_exp_f32 v144, v144
    v_exp_f32 v145, v145
    v_exp_f32 v146, v146
    v_exp_f32 v147, v147
    v_exp_f32 v148, v148
    v_exp_f32 v149, v149
    v_exp_f32 v150, v150
    v_exp_f32 v151, v151
    v_cvt_pk_bf16_f32 v232, v136, v137
    v_cvt_pk_bf16_f32 v233, v138, v139
    v_cvt_pk_bf16_f32 v234, v140, v141
    v_cvt_pk_bf16_f32 v235, v142, v143
    v_cvt_pk_bf16_f32 v236, v144, v145
    v_cvt_pk_bf16_f32 v237, v146, v147
    v_cvt_pk_bf16_f32 v238, v148, v149
    v_cvt_pk_bf16_f32 v239, v150, v151
    s_waitcnt lgkmcnt(3)
    v_mfma_f32_32x32x16_bf16 v[200:215], v[38:41], v[232:235], v[200:215]
    s_waitcnt lgkmcnt(2)
    v_mfma_f32_32x32x16_bf16 v[200:215], v[42:45], v[236:239], v[200:215]
    v_exp_f32 v152, v152
    v_exp_f32 v153, v153
    v_exp_f32 v154, v154
    v_exp_f32 v155, v155
    v_exp_f32 v156, v156
    v_exp_f32 v157, v157
    v_exp_f32 v158, v158
    v_exp_f32 v159, v159
    v_exp_f32 v160, v160
    v_exp_f32 v161, v161
    v_exp_f32 v162, v162
    v_exp_f32 v163, v163
    v_exp_f32 v164, v164
    v_exp_f32 v165, v165
    v_exp_f32 v166, v166
    v_exp_f32 v167, v167
    v_cvt_pk_bf16_f32 v240, v152, v153
    v_cvt_pk_bf16_f32 v241, v154, v155
    v_cvt_pk_bf16_f32 v242, v156, v157
    v_cvt_pk_bf16_f32 v243, v158, v159
    v_cvt_pk_bf16_f32 v244, v160, v161
    v_cvt_pk_bf16_f32 v245, v162, v163
    v_cvt_pk_bf16_f32 v246, v164, v165
    v_cvt_pk_bf16_f32 v247, v166, v167
    s_waitcnt lgkmcnt(1)
    v_mfma_f32_32x32x16_bf16 v[216:231], v[46:49], v[240:243], v[216:231]
    s_waitcnt lgkmcnt(0)
    v_mfma_f32_32x32x16_bf16 v[216:231], v[50:53], v[244:247], v[216:231]
    v_add_u32 v32, 4128, v32
    v_add_u32 v33, 4128, v33
    v_add_u32 v34, 4128, v34
    s_nop 8
    s_add_u32 s89, s89, 1
    s_cmp_le_u32 s89, 8
    s_cbranch_scc1 L_FBB
    s_mov_b64 s[100:101], 0
    s_branch L_FBR
L_CODE_END:
.set CODE_BYTES, L_CODE_END - gated_mix__sliding_block__mixer_channel_mlp__prompt_kernel - 4
.section .rodata,"a"
.p2align 6
.amdhsa_kernel gated_mix__sliding_block__mixer_channel_mlp__prompt_kernel
  .amdhsa_next_free_vgpr 512
  .amdhsa_next_free_sgpr 102
  .amdhsa_accum_offset 256
  .amdhsa_group_segment_fixed_size 0
  .amdhsa_kernarg_size 96
  .amdhsa_user_sgpr_count 2
  .amdhsa_user_sgpr_kernarg_segment_ptr 1
  .amdhsa_system_sgpr_workgroup_id_x 1
.end_amdhsa_kernel
```
